```python
import torch

def _softmax(x, axis=-1):
    return torch.softmax(x, dim=axis)
def _gelu(x):
    return torch.nn.functional.gelu(x, approximate="tanh")
def _silu(x):
    return torch.nn.functional.silu(x)
def _sigmoid(x):
    return torch.sigmoid(x)
def _layernorm(x, axis=-1, eps=1e-5):
    m = x.mean(dim=axis, keepdim=True)
    v = x.var(dim=axis, keepdim=True, unbiased=False)
    return (x - m) / torch.sqrt(v + eps)
def _scatter_add(tgt, idx, src, axis=0):
    return tgt.clone().index_add_(axis, idx, src)
def _segment_sum(src, seg, n):
    out = torch.zeros((n,) + src.shape[1:], dtype=src.dtype)
    return out.index_add_(0, seg, src)
def _pad(x, pw):
    flat = tuple(v for pair in reversed(pw) for v in pair)
    return torch.nn.functional.pad(x, flat)

kernel_name = 'gated_mix__grouped_kv_mqa__dense_activation_mish__prompt'

def setup_inputs():

    _w = (lambda a: (lambda t: t.to(torch.bfloat16) if t.is_floating_point() else t)(torch.as_tensor(a)))
    def _A_setup():
        B, S, D, H = 1, 2048, 512, 32
        Dh = D // H
        return {
            "x": _w((lambda *s: torch.randn(*s, dtype=torch.bfloat16) * 0.05)(B, S, D)),
            "wq": _w((lambda *s: torch.randn(*s, dtype=torch.bfloat16) * 0.8)(D, H * Dh)),
            "wk": _w((lambda *s: torch.randn(*s, dtype=torch.bfloat16) * 0.8)(D, Dh)),
            "wv": _w((lambda *s: torch.randn(*s, dtype=torch.bfloat16) * 0.05)(D, Dh)),
            "wo": _w((lambda *s: torch.randn(*s, dtype=torch.bfloat16) * 0.05)(H * Dh, D)),
        }
    _A_in = _A_setup()

    def _B_setup():
        B, S, D, F = 1, 2048, 512, 1792
        return {
            "x": _w((lambda *s: torch.randn(*s, dtype=torch.bfloat16) * 0.05)(B, S, D)),
            "w1": _w((lambda *s: torch.randn(*s, dtype=torch.bfloat16) * 3.2)(D, F) * (D ** -0.5)),
            "b1": _w((lambda *s: torch.randn(*s, dtype=torch.bfloat16) * 0.05)(F)),
            "w2": _w((lambda *s: torch.randn(*s, dtype=torch.bfloat16) * 0.05)(F, D) * (F ** -0.5)),
        }
    _B_in = _B_setup()

    return {
        "A_x": _A_in["x"],
        "A_wq": _A_in["wq"],
        "A_wk": _A_in["wk"],
        "A_wv": _A_in["wv"],
        "A_wo": _A_in["wo"],
        "B_x": _B_in["x"],
        "B_w1": _B_in["w1"],
        "B_b1": _B_in["b1"],
        "B_w2": _B_in["w2"],
        "gate_w": _w((lambda *s: torch.randn(*s, dtype=torch.bfloat16) * 0.05)(512) * 16.0),
    }

def reference(A_x, A_wq, A_wk, A_wv, A_wo, B_x, B_w1, B_b1, B_w2, gate_w):
    def _A_ref(x, wq, wk, wv, wo):
        B, S, D = x.shape
        H = 32
        Dh = D // H
        q = (lambda x, *d: x.permute(*d))((x @ wq).reshape(B, S, H, Dh), 0, 2, 1, 3)
        k = x @ wk
        v = x @ wv
        scores = torch.einsum("bhqd,bkd->bhqk", q, k) * (Dh ** -0.5)
        p = _softmax(scores, axis=-1)
        o = torch.einsum("bhqk,bkd->bhqd", p, v)
        return (lambda x, *d: x.permute(*d))(o, 0, 2, 1, 3).reshape(B, S, H * Dh) @ wo

    def _B_ref(x, w1, b1, w2):
        h = torch.einsum("bsd,df->bsf", x, w1) + b1
        sp = torch.log1p(torch.exp(-torch.abs(h))) + torch.where(h > 0, h, torch.zeros_like(h))
        act = h * torch.tanh(sp)
        return torch.einsum("bsf,fd->bsd", act, w2)

    x = A_x
    g = _sigmoid((x * gate_w).sum(-1, keepdims=True))
    a = _A_ref(x, A_wq, A_wk, A_wv, A_wo)
    b = _B_ref(x, B_w1, B_b1, B_w2)
    return g * a + (1 - g) * b
```

```asm
; @launch kernel=gm_k1_kernel grid=(256,1,1) block=(256,1,1) lds=156672
; @launch kernel=gm_k2_kernel grid=(256,1,1) block=(512,1,1) lds=163840
.amdgcn_target "amdgcn-amd-amdhsa--gfx950"
.text
.globl gm_k1_kernel
.p2align 8
.type gm_k1_kernel,@function
gm_k1_kernel:
    s_cmp_ge_u32 s2, 256
    s_cbranch_scc1 L_k1_end
    s_load_dwordx16 s[36:51], s[0:1], 0
    s_load_dwordx4 s[52:55], s[0:1], 64
    s_load_dwordx2 s[56:57], s[0:1], 96
    v_and_b32 v1, 63, v0
    v_lshrrev_b32 v2, 6, v0
    s_and_b32 s3, s2, 7
    s_lshr_b32 s35, s2, 3
    v_readfirstlane_b32 s28, v2
    s_and_b32 s29, s35, 1
    s_lshl_b32 s3, s3, 1
    s_add_u32 s29, s29, s3
    s_lshr_b32 s30, s35, 1
    s_lshl_b32 s31, s29, 2
    s_add_u32 s31, s31, s28
    s_cmp_eq_u32 s30, 14
    s_cbranch_scc1 L_k1_special
    s_cmp_eq_u32 s30, 15
    s_cbranch_scc1 L_k1_shuffle
L_k1_main:
    v_lshrrev_b32 v17, 3, v1
    v_lshrrev_b32 v18, 4, v1
    v_and_b32 v19, 7, v1
    v_add_u32 v2, 0, v18
    v_xor_b32 v2, v2, v19
    v_lshlrev_b32 v2, 4, v2
    v_add_u32 v148, 0, v17
    v_lshlrev_b32 v148, 10, v148
    v_add_u32 v2, v2, v148
    v_add_u32 v3, 4, v18
    v_xor_b32 v3, v3, v19
    v_lshlrev_b32 v3, 4, v3
    v_add_u32 v148, 8, v17
    v_lshlrev_b32 v148, 10, v148
    v_add_u32 v3, v3, v148
    v_add_u32 v4, 0, v18
    v_xor_b32 v4, v4, v19
    v_lshlrev_b32 v4, 4, v4
    v_add_u32 v148, 16, v17
    v_lshlrev_b32 v148, 10, v148
    v_add_u32 v4, v4, v148
    v_add_u32 v5, 4, v18
    v_xor_b32 v5, v5, v19
    v_lshlrev_b32 v5, 4, v5
    v_add_u32 v148, 24, v17
    v_lshlrev_b32 v148, 10, v148
    v_add_u32 v5, v5, v148
    v_and_b32 v17, 31, v1
    v_lshrrev_b32 v18, 5, v1
    v_lshrrev_b32 v19, 1, v17
    v_and_b32 v19, 7, v19
    v_xor_b32 v19, v19, v18
    v_lshlrev_b32 v17, 7, v17
    s_lshl_b32 s35, s28, 12
    v_add_u32 v17, s35, v17
    v_xor_b32 v8, 0, v19
    v_lshlrev_b32 v8, 4, v8
    v_add_u32 v8, v8, v17
    v_xor_b32 v9, 2, v19
    v_lshlrev_b32 v9, 4, v9
    v_add_u32 v9, v9, v17
    v_xor_b32 v10, 4, v19
    v_lshlrev_b32 v10, 4, v10
    v_add_u32 v10, v10, v17
    v_xor_b32 v11, 6, v19
    v_lshlrev_b32 v11, 4, v11
    v_add_u32 v11, v11, v17
    v_lshrrev_b32 v17, 2, v1
    v_lshlrev_b32 v17, 10, v17
    v_and_b32 v18, 3, v1
    v_lshlrev_b32 v18, 4, v18
    v_add_u32 v6, v17, v18
    v_lshrrev_b32 v17, 5, v1
    v_lshlrev_b32 v17, 3, v17
    v_bfe_u32 v18, v1, 2, 2
    v_add_u32 v17, v17, v18
    v_bfe_u32 v19, v1, 4, 1
    v_and_b32 v148, 3, v1
    v_lshlrev_b32 v148, 3, v148
    v_lshl_add_u32 v148, v19, 5, v148
    v_lshl_add_u32 v12, v17, 6, v148
    s_lshl_b32 s32, s31, 15
    s_lshl_b32 s58, s28, 12
    v_add_u32 v12, 131072, v12
    v_lshl_add_u32 v149, v17, 8, v148
    v_add_u32 v149, 65536, v149
    s_and_b32 s62, s28, 1
    s_lshl_b32 s62, s62, 1
    s_add_u32 s63, s62, 0
    v_xor_b32 v13, s63, v18
    v_lshl_add_u32 v13, v13, 6, v149
    s_add_u32 s63, s62, 1
    v_xor_b32 v14, s63, v18
    v_lshl_add_u32 v14, v14, 6, v149
    v_xor_b32 v180, 4096, v8
    v_xor_b32 v181, 4096, v9
    v_xor_b32 v182, 4096, v10
    v_xor_b32 v183, 4096, v11
    v_lshrrev_b32 v17, 4, v1
    v_and_b32 v18, 15, v1
    v_lshlrev_b32 v19, 2, v17
    v_xor_b32 v18, v18, v19
    v_lshlrev_b32 v18, 4, v18
    v_mul_u32_u24 v17, 3584, v17
    v_add_u32 v7, v17, v18
    s_lshl_b32 s33, s28, 14
    s_lshl_b32 s35, s30, 6
    s_add_u32 s33, s33, s35
    s_lshl_b32 s59, s28, 10
    s_add_u32 s59, s59, 131072
    s_mul_i32 s34, s28, 57344
    s_lshl_b32 s35, s30, 8
    s_add_u32 s34, s34, s35
    s_lshl_b32 s60, s28, 12
    s_add_u32 s60, s60, 65536
    v_lshrrev_b32 v17, 5, v1
    v_lshlrev_b32 v17, 3, v17
    s_lshl_b32 s62, s62, 6
    s_add_u32 s35, s35, s62
    s_waitcnt lgkmcnt(0)
    s_mov_b32 s4, s36
    s_mov_b32 s5, s37
    s_mov_b32 s6, 0x200000
    s_mov_b32 s7, 0x00020000
    s_mov_b32 s8, s38
    s_mov_b32 s9, s39
    s_mov_b32 s10, 0x80000
    s_mov_b32 s11, 0x00020000
    s_mov_b32 s16, s56
    s_mov_b32 s17, s57
    s_mov_b32 s18, 0x1000000
    s_mov_b32 s19, 0x00020000
    s_mov_b32 s12, s48
    s_mov_b32 s13, s49
    s_mov_b32 s14, 0x1c0000
    s_mov_b32 s15, 0x00020000
    s_mov_b32 s20, s50
    s_mov_b32 s21, s51
    s_mov_b32 s22, 0xe00
    s_mov_b32 s23, 0x00020000
    s_mov_b32 m0, s58
    s_nop 0
    buffer_load_dwordx4 v2, s[4:7], s32 offen lds
    s_add_u32 m0, s58, 1024
    s_nop 0
    buffer_load_dwordx4 v3, s[4:7], s32 offen lds
    s_add_u32 m0, s58, 2048
    s_nop 0
    buffer_load_dwordx4 v4, s[4:7], s32 offen lds
    s_add_u32 m0, s58, 3072
    s_nop 0
    buffer_load_dwordx4 v5, s[4:7], s32 offen lds
    s_mov_b32 m0, s59
    s_nop 0
    buffer_load_dwordx4 v6, s[8:11], s33 offen lds
    s_mov_b32 m0, s60
    s_nop 0
    buffer_load_dwordx4 v7, s[12:15], s34 offen lds
    s_add_u32 m0, s60, 1024
    s_add_u32 s61, s34, 14336
    buffer_load_dwordx4 v7, s[12:15], s61 offen lds
    s_add_u32 m0, s60, 2048
    s_add_u32 s61, s34, 28672
    buffer_load_dwordx4 v7, s[12:15], s61 offen lds
    s_add_u32 m0, s60, 3072
    s_add_u32 s61, s34, 43008
    buffer_load_dwordx4 v7, s[12:15], s61 offen lds
    buffer_load_dwordx2 v[108:109], v17, s[20:23], s35 offen offset:0
    buffer_load_dwordx2 v[110:111], v17, s[20:23], s35 offen offset:16
    buffer_load_dwordx2 v[112:113], v17, s[20:23], s35 offen offset:32
    buffer_load_dwordx2 v[114:115], v17, s[20:23], s35 offen offset:48
    buffer_load_dwordx2 v[116:117], v17, s[20:23], s35 offen offset:64
    buffer_load_dwordx2 v[118:119], v17, s[20:23], s35 offen offset:80
    buffer_load_dwordx2 v[120:121], v17, s[20:23], s35 offen offset:96
    buffer_load_dwordx2 v[122:123], v17, s[20:23], s35 offen offset:112
    s_add_u32 m0, s58, 16384
    s_add_u32 s61, s32, 128
    buffer_load_dwordx4 v2, s[4:7], s61 offen lds
    s_add_u32 m0, s58, 17408
    s_add_u32 s61, s32, 128
    buffer_load_dwordx4 v3, s[4:7], s61 offen lds
    s_add_u32 m0, s58, 18432
    s_add_u32 s61, s32, 128
    buffer_load_dwordx4 v4, s[4:7], s61 offen lds
    s_add_u32 m0, s58, 19456
    s_add_u32 s61, s32, 128
    buffer_load_dwordx4 v5, s[4:7], s61 offen lds
    s_add_u32 m0, s59, 4096
    s_add_u32 s61, s33, 65536
    buffer_load_dwordx4 v6, s[8:11], s61 offen lds
    s_add_u32 m0, s60, 16384
    s_add_u32 s61, s34, 229376
    buffer_load_dwordx4 v7, s[12:15], s61 offen lds
    s_add_u32 m0, s60, 17408
    s_add_u32 s61, s34, 243712
    buffer_load_dwordx4 v7, s[12:15], s61 offen lds
    s_add_u32 m0, s60, 18432
    s_add_u32 s61, s34, 258048
    buffer_load_dwordx4 v7, s[12:15], s61 offen lds
    s_add_u32 m0, s60, 19456
    s_add_u32 s61, s34, 272384
    buffer_load_dwordx4 v7, s[12:15], s61 offen lds
    s_add_u32 m0, s58, 32768
    s_add_u32 s61, s32, 256
    buffer_load_dwordx4 v2, s[4:7], s61 offen lds
    s_add_u32 m0, s58, 33792
    s_add_u32 s61, s32, 256
    buffer_load_dwordx4 v3, s[4:7], s61 offen lds
    s_add_u32 m0, s58, 34816
    s_add_u32 s61, s32, 256
    buffer_load_dwordx4 v4, s[4:7], s61 offen lds
    s_add_u32 m0, s58, 35840
    s_add_u32 s61, s32, 256
    buffer_load_dwordx4 v5, s[4:7], s61 offen lds
    s_add_u32 m0, s59, 8192
    s_add_u32 s61, s33, 131072
    buffer_load_dwordx4 v6, s[8:11], s61 offen lds
    s_add_u32 m0, s60, 32768
    s_add_u32 s61, s34, 458752
    buffer_load_dwordx4 v7, s[12:15], s61 offen lds
    s_add_u32 m0, s60, 33792
    s_add_u32 s61, s34, 473088
    buffer_load_dwordx4 v7, s[12:15], s61 offen lds
    s_add_u32 m0, s60, 34816
    s_add_u32 s61, s34, 487424
    buffer_load_dwordx4 v7, s[12:15], s61 offen lds
    s_add_u32 m0, s60, 35840
    s_add_u32 s61, s34, 501760
    buffer_load_dwordx4 v7, s[12:15], s61 offen lds
    s_waitcnt vmcnt(18)
    v_lshlrev_b32 v36, 16, v108
    v_and_b32 v37, 0xffff0000, v108
    v_lshlrev_b32 v38, 16, v109
    v_and_b32 v39, 0xffff0000, v109
    v_lshlrev_b32 v40, 16, v110
    v_and_b32 v41, 0xffff0000, v110
    v_lshlrev_b32 v42, 16, v111
    v_and_b32 v43, 0xffff0000, v111
    v_lshlrev_b32 v44, 16, v112
    v_and_b32 v45, 0xffff0000, v112
    v_lshlrev_b32 v46, 16, v113
    v_and_b32 v47, 0xffff0000, v113
    v_lshlrev_b32 v48, 16, v114
    v_and_b32 v49, 0xffff0000, v114
    v_lshlrev_b32 v50, 16, v115
    v_and_b32 v51, 0xffff0000, v115
    v_lshlrev_b32 v52, 16, v108
    v_and_b32 v53, 0xffff0000, v108
    v_lshlrev_b32 v54, 16, v109
    v_and_b32 v55, 0xffff0000, v109
    v_lshlrev_b32 v56, 16, v110
    v_and_b32 v57, 0xffff0000, v110
    v_lshlrev_b32 v58, 16, v111
    v_and_b32 v59, 0xffff0000, v111
    v_lshlrev_b32 v60, 16, v112
    v_and_b32 v61, 0xffff0000, v112
    v_lshlrev_b32 v62, 16, v113
    v_and_b32 v63, 0xffff0000, v113
    v_lshlrev_b32 v64, 16, v114
    v_and_b32 v65, 0xffff0000, v114
    v_lshlrev_b32 v66, 16, v115
    v_and_b32 v67, 0xffff0000, v115
    v_lshlrev_b32 v68, 16, v116
    v_and_b32 v69, 0xffff0000, v116
    v_lshlrev_b32 v70, 16, v117
    v_and_b32 v71, 0xffff0000, v117
    v_lshlrev_b32 v72, 16, v118
    v_and_b32 v73, 0xffff0000, v118
    v_lshlrev_b32 v74, 16, v119
    v_and_b32 v75, 0xffff0000, v119
    v_lshlrev_b32 v76, 16, v120
    v_and_b32 v77, 0xffff0000, v120
    v_lshlrev_b32 v78, 16, v121
    v_and_b32 v79, 0xffff0000, v121
    v_lshlrev_b32 v80, 16, v122
    v_and_b32 v81, 0xffff0000, v122
    v_lshlrev_b32 v82, 16, v123
    v_and_b32 v83, 0xffff0000, v123
    v_lshlrev_b32 v84, 16, v116
    v_and_b32 v85, 0xffff0000, v116
    v_lshlrev_b32 v86, 16, v117
    v_and_b32 v87, 0xffff0000, v117
    v_lshlrev_b32 v88, 16, v118
    v_and_b32 v89, 0xffff0000, v118
    v_lshlrev_b32 v90, 16, v119
    v_and_b32 v91, 0xffff0000, v119
    v_lshlrev_b32 v92, 16, v120
    v_and_b32 v93, 0xffff0000, v120
    v_lshlrev_b32 v94, 16, v121
    v_and_b32 v95, 0xffff0000, v121
    v_lshlrev_b32 v96, 16, v122
    v_and_b32 v97, 0xffff0000, v122
    v_lshlrev_b32 v98, 16, v123
    v_and_b32 v99, 0xffff0000, v123
    s_waitcnt vmcnt(18)
    s_barrier
    ds_read_b128 v[100:103], v8 offset:0
    ds_read_b64_tr_b16 v[108:109], v12 offset:0
    ds_read_b64_tr_b16 v[110:111], v12 offset:256
    ds_read_b64_tr_b16 v[112:113], v13 offset:0
    ds_read_b64_tr_b16 v[114:115], v13 offset:1024
    ds_read_b128 v[120:123], v180 offset:0
    ds_read_b64_tr_b16 v[116:117], v14 offset:0
    ds_read_b64_tr_b16 v[118:119], v14 offset:1024
    s_waitcnt lgkmcnt(5)
    v_mfma_f32_32x32x16_bf16 v[20:35], v[108:111], v[100:103], 0
    ds_read_b128 v[104:107], v9 offset:0
    ds_read_b64_tr_b16 v[128:129], v12 offset:1024
    ds_read_b64_tr_b16 v[130:131], v12 offset:1280
    s_waitcnt lgkmcnt(6)
    v_mfma_f32_32x32x16_bf16 v[36:51], v[112:115], v[100:103], v[36:51]
    ds_read_b64_tr_b16 v[132:133], v13 offset:4096
    ds_read_b64_tr_b16 v[134:135], v13 offset:5120
    s_waitcnt lgkmcnt(7)
    v_mfma_f32_32x32x16_bf16 v[52:67], v[112:115], v[120:123], v[52:67]
    ds_read_b128 v[140:143], v181 offset:0
    s_waitcnt lgkmcnt(6)
    v_mfma_f32_32x32x16_bf16 v[68:83], v[116:119], v[100:103], v[68:83]
    ds_read_b64_tr_b16 v[136:137], v14 offset:4096
    ds_read_b64_tr_b16 v[138:139], v14 offset:5120
    s_waitcnt lgkmcnt(8)
    v_mfma_f32_32x32x16_bf16 v[84:99], v[116:119], v[120:123], v[84:99]
    s_waitcnt lgkmcnt(5)
    v_mfma_f32_32x32x16_bf16 v[20:35], v[128:131], v[104:107], v[20:35]
    ds_read_b128 v[100:103], v10 offset:0
    ds_read_b64_tr_b16 v[108:109], v12 offset:2048
    ds_read_b64_tr_b16 v[110:111], v12 offset:2304
    s_waitcnt lgkmcnt(6)
    v_mfma_f32_32x32x16_bf16 v[36:51], v[132:135], v[104:107], v[36:51]
    ds_read_b64_tr_b16 v[112:113], v13 offset:8192
    ds_read_b64_tr_b16 v[114:115], v13 offset:9216
    s_waitcnt lgkmcnt(7)
    v_mfma_f32_32x32x16_bf16 v[52:67], v[132:135], v[140:143], v[52:67]
    ds_read_b128 v[120:123], v182 offset:0
    s_waitcnt lgkmcnt(6)
    v_mfma_f32_32x32x16_bf16 v[68:83], v[136:139], v[104:107], v[68:83]
    ds_read_b64_tr_b16 v[116:117], v14 offset:8192
    ds_read_b64_tr_b16 v[118:119], v14 offset:9216
    s_waitcnt lgkmcnt(8)
    v_mfma_f32_32x32x16_bf16 v[84:99], v[136:139], v[140:143], v[84:99]
    s_waitcnt lgkmcnt(5)
    v_mfma_f32_32x32x16_bf16 v[20:35], v[108:111], v[100:103], v[20:35]
    ds_read_b128 v[104:107], v11 offset:0
    ds_read_b64_tr_b16 v[128:129], v12 offset:3072
    ds_read_b64_tr_b16 v[130:131], v12 offset:3328
    s_waitcnt lgkmcnt(6)
    v_mfma_f32_32x32x16_bf16 v[36:51], v[112:115], v[100:103], v[36:51]
    ds_read_b64_tr_b16 v[132:133], v13 offset:12288
    ds_read_b64_tr_b16 v[134:135], v13 offset:13312
    s_waitcnt lgkmcnt(7)
    v_mfma_f32_32x32x16_bf16 v[52:67], v[112:115], v[120:123], v[52:67]
    ds_read_b128 v[140:143], v183 offset:0
    s_waitcnt lgkmcnt(6)
    v_mfma_f32_32x32x16_bf16 v[68:83], v[116:119], v[100:103], v[68:83]
    ds_read_b64_tr_b16 v[136:137], v14 offset:12288
    ds_read_b64_tr_b16 v[138:139], v14 offset:13312
    s_waitcnt lgkmcnt(8)
    v_mfma_f32_32x32x16_bf16 v[84:99], v[116:119], v[120:123], v[84:99]
    s_waitcnt lgkmcnt(5)
    v_mfma_f32_32x32x16_bf16 v[20:35], v[128:131], v[104:107], v[20:35]
    s_waitcnt vmcnt(9)
    s_barrier
    ds_read_b128 v[100:103], v8 offset:16384
    ds_read_b64_tr_b16 v[108:109], v12 offset:4096
    ds_read_b64_tr_b16 v[110:111], v12 offset:4352
    s_waitcnt lgkmcnt(6)
    v_mfma_f32_32x32x16_bf16 v[36:51], v[132:135], v[104:107], v[36:51]
    ds_read_b64_tr_b16 v[112:113], v13 offset:16384
    ds_read_b64_tr_b16 v[114:115], v13 offset:17408
    s_add_u32 m0, s58, 49152
    s_add_u32 s61, s32, 384
    buffer_load_dwordx4 v2, s[4:7], s61 offen lds
    s_waitcnt lgkmcnt(7)
    v_mfma_f32_32x32x16_bf16 v[52:67], v[132:135], v[140:143], v[52:67]
    ds_read_b128 v[120:123], v180 offset:16384
    s_add_u32 m0, s58, 50176
    s_add_u32 s61, s32, 384
    buffer_load_dwordx4 v3, s[4:7], s61 offen lds
    s_waitcnt lgkmcnt(6)
    v_mfma_f32_32x32x16_bf16 v[68:83], v[136:139], v[104:107], v[68:83]
    ds_read_b64_tr_b16 v[116:117], v14 offset:16384
    ds_read_b64_tr_b16 v[118:119], v14 offset:17408
    s_add_u32 m0, s58, 51200
    s_add_u32 s61, s32, 384
    buffer_load_dwordx4 v4, s[4:7], s61 offen lds
    s_waitcnt lgkmcnt(8)
    v_mfma_f32_32x32x16_bf16 v[84:99], v[136:139], v[140:143], v[84:99]
    s_add_u32 m0, s58, 52224
    s_add_u32 s61, s32, 384
    buffer_load_dwordx4 v5, s[4:7], s61 offen lds
    s_waitcnt lgkmcnt(5)
    v_mfma_f32_32x32x16_bf16 v[20:35], v[108:111], v[100:103], v[20:35]
    ds_read_b128 v[104:107], v9 offset:16384
    ds_read_b64_tr_b16 v[128:129], v12 offset:5120
    ds_read_b64_tr_b16 v[130:131], v12 offset:5376
    s_add_u32 m0, s59, 12288
    s_add_u32 s61, s33, 196608
    buffer_load_dwordx4 v6, s[8:11], s61 offen lds
    s_waitcnt lgkmcnt(6)
    v_mfma_f32_32x32x16_bf16 v[36:51], v[112:115], v[100:103], v[36:51]
    ds_read_b64_tr_b16 v[132:133], v13 offset:20480
    ds_read_b64_tr_b16 v[134:135], v13 offset:21504
    s_add_u32 m0, s60, 49152
    s_add_u32 s61, s34, 688128
    buffer_load_dwordx4 v7, s[12:15], s61 offen lds
    s_waitcnt lgkmcnt(7)
    v_mfma_f32_32x32x16_bf16 v[52:67], v[112:115], v[120:123], v[52:67]
    ds_read_b128 v[140:143], v181 offset:16384
    s_add_u32 m0, s60, 50176
    s_add_u32 s61, s34, 702464
    buffer_load_dwordx4 v7, s[12:15], s61 offen lds
    s_waitcnt lgkmcnt(6)
    v_mfma_f32_32x32x16_bf16 v[68:83], v[116:119], v[100:103], v[68:83]
    ds_read_b64_tr_b16 v[136:137], v14 offset:20480
    ds_read_b64_tr_b16 v[138:139], v14 offset:21504
    s_add_u32 m0, s60, 51200
    s_add_u32 s61, s34, 716800
    buffer_load_dwordx4 v7, s[12:15], s61 offen lds
    s_waitcnt lgkmcnt(8)
    v_mfma_f32_32x32x16_bf16 v[84:99], v[116:119], v[120:123], v[84:99]
    s_add_u32 m0, s60, 52224
    s_add_u32 s61, s34, 731136
    buffer_load_dwordx4 v7, s[12:15], s61 offen lds
    s_waitcnt lgkmcnt(5)
    v_mfma_f32_32x32x16_bf16 v[20:35], v[128:131], v[104:107], v[20:35]
    ds_read_b128 v[100:103], v10 offset:16384
    ds_read_b64_tr_b16 v[108:109], v12 offset:6144
    ds_read_b64_tr_b16 v[110:111], v12 offset:6400
    s_waitcnt lgkmcnt(6)
    v_mfma_f32_32x32x16_bf16 v[36:51], v[132:135], v[104:107], v[36:51]
    ds_read_b64_tr_b16 v[112:113], v13 offset:24576
    ds_read_b64_tr_b16 v[114:115], v13 offset:25600
    s_waitcnt lgkmcnt(7)
    v_mfma_f32_32x32x16_bf16 v[52:67], v[132:135], v[140:143], v[52:67]
    ds_read_b128 v[120:123], v182 offset:16384
    s_waitcnt lgkmcnt(6)
    v_mfma_f32_32x32x16_bf16 v[68:83], v[136:139], v[104:107], v[68:83]
    ds_read_b64_tr_b16 v[116:117], v14 offset:24576
    ds_read_b64_tr_b16 v[118:119], v14 offset:25600
    s_waitcnt lgkmcnt(8)
    v_mfma_f32_32x32x16_bf16 v[84:99], v[136:139], v[140:143], v[84:99]
    s_waitcnt lgkmcnt(5)
    v_mfma_f32_32x32x16_bf16 v[20:35], v[108:111], v[100:103], v[20:35]
    ds_read_b128 v[104:107], v11 offset:16384
    ds_read_b64_tr_b16 v[128:129], v12 offset:7168
    ds_read_b64_tr_b16 v[130:131], v12 offset:7424
    s_waitcnt lgkmcnt(6)
    v_mfma_f32_32x32x16_bf16 v[36:51], v[112:115], v[100:103], v[36:51]
    ds_read_b64_tr_b16 v[132:133], v13 offset:28672
    ds_read_b64_tr_b16 v[134:135], v13 offset:29696
    s_waitcnt lgkmcnt(7)
    v_mfma_f32_32x32x16_bf16 v[52:67], v[112:115], v[120:123], v[52:67]
    ds_read_b128 v[140:143], v183 offset:16384
    s_waitcnt lgkmcnt(6)
    v_mfma_f32_32x32x16_bf16 v[68:83], v[116:119], v[100:103], v[68:83]
    ds_read_b64_tr_b16 v[136:137], v14 offset:28672
    ds_read_b64_tr_b16 v[138:139], v14 offset:29696
    s_waitcnt lgkmcnt(8)
    v_mfma_f32_32x32x16_bf16 v[84:99], v[116:119], v[120:123], v[84:99]
    s_waitcnt lgkmcnt(5)
    v_mfma_f32_32x32x16_bf16 v[20:35], v[128:131], v[104:107], v[20:35]
    s_waitcnt vmcnt(9)
    s_barrier
    ds_read_b128 v[100:103], v8 offset:32768
    ds_read_b64_tr_b16 v[108:109], v12 offset:8192
    ds_read_b64_tr_b16 v[110:111], v12 offset:8448
    s_waitcnt lgkmcnt(6)
    v_mfma_f32_32x32x16_bf16 v[36:51], v[132:135], v[104:107], v[36:51]
    ds_read_b64_tr_b16 v[112:113], v13 offset:32768
    ds_read_b64_tr_b16 v[114:115], v13 offset:33792
    s_mov_b32 m0, s58
    s_add_u32 s61, s32, 512
    buffer_load_dwordx4 v2, s[4:7], s61 offen lds
    s_waitcnt lgkmcnt(7)
    v_mfma_f32_32x32x16_bf16 v[52:67], v[132:135], v[140:143], v[52:67]
    ds_read_b128 v[120:123], v180 offset:32768
    s_add_u32 m0, s58, 1024
    s_add_u32 s61, s32, 512
    buffer_load_dwordx4 v3, s[4:7], s61 offen lds
    s_waitcnt lgkmcnt(6)
    v_mfma_f32_32x32x16_bf16 v[68:83], v[136:139], v[104:107], v[68:83]
    ds_read_b64_tr_b16 v[116:117], v14 offset:32768
    ds_read_b64_tr_b16 v[118:119], v14 offset:33792
    s_add_u32 m0, s58, 2048
    s_add_u32 s61, s32, 512
    buffer_load_dwordx4 v4, s[4:7], s61 offen lds
    s_waitcnt lgkmcnt(8)
    v_mfma_f32_32x32x16_bf16 v[84:99], v[136:139], v[140:143], v[84:99]
    s_add_u32 m0, s58, 3072
    s_add_u32 s61, s32, 512
    buffer_load_dwordx4 v5, s[4:7], s61 offen lds
    s_waitcnt lgkmcnt(5)
    v_mfma_f32_32x32x16_bf16 v[20:35], v[108:111], v[100:103], v[20:35]
    ds_read_b128 v[104:107], v9 offset:32768
    ds_read_b64_tr_b16 v[128:129], v12 offset:9216
    ds_read_b64_tr_b16 v[130:131], v12 offset:9472
    s_mov_b32 m0, s59
    s_add_u32 s61, s33, 262144
    buffer_load_dwordx4 v6, s[8:11], s61 offen lds
    s_waitcnt lgkmcnt(6)
    v_mfma_f32_32x32x16_bf16 v[36:51], v[112:115], v[100:103], v[36:51]
    ds_read_b64_tr_b16 v[132:133], v13 offset:36864
    ds_read_b64_tr_b16 v[134:135], v13 offset:37888
    s_mov_b32 m0, s60
    s_add_u32 s61, s34, 917504
    buffer_load_dwordx4 v7, s[12:15], s61 offen lds
    s_waitcnt lgkmcnt(7)
    v_mfma_f32_32x32x16_bf16 v[52:67], v[112:115], v[120:123], v[52:67]
    ds_read_b128 v[140:143], v181 offset:32768
    s_add_u32 m0, s60, 1024
    s_add_u32 s61, s34, 931840
    buffer_load_dwordx4 v7, s[12:15], s61 offen lds
    s_waitcnt lgkmcnt(6)
    v_mfma_f32_32x32x16_bf16 v[68:83], v[116:119], v[100:103], v[68:83]
    ds_read_b64_tr_b16 v[136:137], v14 offset:36864
    ds_read_b64_tr_b16 v[138:139], v14 offset:37888
    s_add_u32 m0, s60, 2048
    s_add_u32 s61, s34, 946176
    buffer_load_dwordx4 v7, s[12:15], s61 offen lds
    s_waitcnt lgkmcnt(8)
    v_mfma_f32_32x32x16_bf16 v[84:99], v[116:119], v[120:123], v[84:99]
    s_add_u32 m0, s60, 3072
    s_add_u32 s61, s34, 960512
    buffer_load_dwordx4 v7, s[12:15], s61 offen lds
    s_waitcnt lgkmcnt(5)
    v_mfma_f32_32x32x16_bf16 v[20:35], v[128:131], v[104:107], v[20:35]
    ds_read_b128 v[100:103], v10 offset:32768
    ds_read_b64_tr_b16 v[108:109], v12 offset:10240
    ds_read_b64_tr_b16 v[110:111], v12 offset:10496
    s_waitcnt lgkmcnt(6)
    v_mfma_f32_32x32x16_bf16 v[36:51], v[132:135], v[104:107], v[36:51]
    ds_read_b64_tr_b16 v[112:113], v13 offset:40960
    ds_read_b64_tr_b16 v[114:115], v13 offset:41984
    s_waitcnt lgkmcnt(7)
    v_mfma_f32_32x32x16_bf16 v[52:67], v[132:135], v[140:143], v[52:67]
    ds_read_b128 v[120:123], v182 offset:32768
    s_waitcnt lgkmcnt(6)
    v_mfma_f32_32x32x16_bf16 v[68:83], v[136:139], v[104:107], v[68:83]
    ds_read_b64_tr_b16 v[116:117], v14 offset:40960
    ds_read_b64_tr_b16 v[118:119], v14 offset:41984
    s_waitcnt lgkmcnt(8)
    v_mfma_f32_32x32x16_bf16 v[84:99], v[136:139], v[140:143], v[84:99]
    s_waitcnt lgkmcnt(5)
    v_mfma_f32_32x32x16_bf16 v[20:35], v[108:111], v[100:103], v[20:35]
    ds_read_b128 v[104:107], v11 offset:32768
    ds_read_b64_tr_b16 v[128:129], v12 offset:11264
    ds_read_b64_tr_b16 v[130:131], v12 offset:11520
    s_waitcnt lgkmcnt(6)
    v_mfma_f32_32x32x16_bf16 v[36:51], v[112:115], v[100:103], v[36:51]
    ds_read_b64_tr_b16 v[132:133], v13 offset:45056
    ds_read_b64_tr_b16 v[134:135], v13 offset:46080
    s_waitcnt lgkmcnt(7)
    v_mfma_f32_32x32x16_bf16 v[52:67], v[112:115], v[120:123], v[52:67]
    ds_read_b128 v[140:143], v183 offset:32768
    s_waitcnt lgkmcnt(6)
    v_mfma_f32_32x32x16_bf16 v[68:83], v[116:119], v[100:103], v[68:83]
    ds_read_b64_tr_b16 v[136:137], v14 offset:45056
    ds_read_b64_tr_b16 v[138:139], v14 offset:46080
    s_waitcnt lgkmcnt(8)
    v_mfma_f32_32x32x16_bf16 v[84:99], v[116:119], v[120:123], v[84:99]
    s_waitcnt lgkmcnt(5)
    v_mfma_f32_32x32x16_bf16 v[20:35], v[128:131], v[104:107], v[20:35]
    s_waitcnt vmcnt(9)
    s_barrier
    ds_read_b128 v[100:103], v8 offset:49152
    ds_read_b64_tr_b16 v[108:109], v12 offset:12288
    ds_read_b64_tr_b16 v[110:111], v12 offset:12544
    s_waitcnt lgkmcnt(6)
    v_mfma_f32_32x32x16_bf16 v[36:51], v[132:135], v[104:107], v[36:51]
    ds_read_b64_tr_b16 v[112:113], v13 offset:49152
    ds_read_b64_tr_b16 v[114:115], v13 offset:50176
    s_add_u32 m0, s58, 16384
    s_add_u32 s61, s32, 640
    buffer_load_dwordx4 v2, s[4:7], s61 offen lds
    s_waitcnt lgkmcnt(7)
    v_mfma_f32_32x32x16_bf16 v[52:67], v[132:135], v[140:143], v[52:67]
    ds_read_b128 v[120:123], v180 offset:49152
    s_add_u32 m0, s58, 17408
    s_add_u32 s61, s32, 640
    buffer_load_dwordx4 v3, s[4:7], s61 offen lds
    s_waitcnt lgkmcnt(6)
    v_mfma_f32_32x32x16_bf16 v[68:83], v[136:139], v[104:107], v[68:83]
    ds_read_b64_tr_b16 v[116:117], v14 offset:49152
    ds_read_b64_tr_b16 v[118:119], v14 offset:50176
    s_add_u32 m0, s58, 18432
    s_add_u32 s61, s32, 640
    buffer_load_dwordx4 v4, s[4:7], s61 offen lds
    s_waitcnt lgkmcnt(8)
    v_mfma_f32_32x32x16_bf16 v[84:99], v[136:139], v[140:143], v[84:99]
    s_add_u32 m0, s58, 19456
    s_add_u32 s61, s32, 640
    buffer_load_dwordx4 v5, s[4:7], s61 offen lds
    s_waitcnt lgkmcnt(5)
    v_mfma_f32_32x32x16_bf16 v[20:35], v[108:111], v[100:103], v[20:35]
    ds_read_b128 v[104:107], v9 offset:49152
    ds_read_b64_tr_b16 v[128:129], v12 offset:13312
    ds_read_b64_tr_b16 v[130:131], v12 offset:13568
    s_add_u32 m0, s59, 4096
    s_add_u32 s61, s33, 327680
    buffer_load_dwordx4 v6, s[8:11], s61 offen lds
    s_waitcnt lgkmcnt(6)
    v_mfma_f32_32x32x16_bf16 v[36:51], v[112:115], v[100:103], v[36:51]
    ds_read_b64_tr_b16 v[132:133], v13 offset:53248
    ds_read_b64_tr_b16 v[134:135], v13 offset:54272
    s_add_u32 m0, s60, 16384
    s_add_u32 s61, s34, 1146880
    buffer_load_dwordx4 v7, s[12:15], s61 offen lds
    s_waitcnt lgkmcnt(7)
    v_mfma_f32_32x32x16_bf16 v[52:67], v[112:115], v[120:123], v[52:67]
    ds_read_b128 v[140:143], v181 offset:49152
    s_add_u32 m0, s60, 17408
    s_add_u32 s61, s34, 1161216
    buffer_load_dwordx4 v7, s[12:15], s61 offen lds
    s_waitcnt lgkmcnt(6)
    v_mfma_f32_32x32x16_bf16 v[68:83], v[116:119], v[100:103], v[68:83]
    ds_read_b64_tr_b16 v[136:137], v14 offset:53248
    ds_read_b64_tr_b16 v[138:139], v14 offset:54272
    s_add_u32 m0, s60, 18432
    s_add_u32 s61, s34, 1175552
    buffer_load_dwordx4 v7, s[12:15], s61 offen lds
    s_waitcnt lgkmcnt(8)
    v_mfma_f32_32x32x16_bf16 v[84:99], v[116:119], v[120:123], v[84:99]
    s_add_u32 m0, s60, 19456
    s_add_u32 s61, s34, 1189888
    buffer_load_dwordx4 v7, s[12:15], s61 offen lds
    s_waitcnt lgkmcnt(5)
    v_mfma_f32_32x32x16_bf16 v[20:35], v[128:131], v[104:107], v[20:35]
    ds_read_b128 v[100:103], v10 offset:49152
    ds_read_b64_tr_b16 v[108:109], v12 offset:14336
    ds_read_b64_tr_b16 v[110:111], v12 offset:14592
    s_waitcnt lgkmcnt(6)
    v_mfma_f32_32x32x16_bf16 v[36:51], v[132:135], v[104:107], v[36:51]
    ds_read_b64_tr_b16 v[112:113], v13 offset:57344
    ds_read_b64_tr_b16 v[114:115], v13 offset:58368
    s_waitcnt lgkmcnt(7)
    v_mfma_f32_32x32x16_bf16 v[52:67], v[132:135], v[140:143], v[52:67]
    ds_read_b128 v[120:123], v182 offset:49152
    s_waitcnt lgkmcnt(6)
    v_mfma_f32_32x32x16_bf16 v[68:83], v[136:139], v[104:107], v[68:83]
    ds_read_b64_tr_b16 v[116:117], v14 offset:57344
    ds_read_b64_tr_b16 v[118:119], v14 offset:58368
    s_waitcnt lgkmcnt(8)
    v_mfma_f32_32x32x16_bf16 v[84:99], v[136:139], v[140:143], v[84:99]
    s_waitcnt lgkmcnt(5)
    v_mfma_f32_32x32x16_bf16 v[20:35], v[108:111], v[100:103], v[20:35]
    ds_read_b128 v[104:107], v11 offset:49152
    ds_read_b64_tr_b16 v[128:129], v12 offset:15360
    ds_read_b64_tr_b16 v[130:131], v12 offset:15616
    s_waitcnt lgkmcnt(6)
    v_mfma_f32_32x32x16_bf16 v[36:51], v[112:115], v[100:103], v[36:51]
    ds_read_b64_tr_b16 v[132:133], v13 offset:61440
    ds_read_b64_tr_b16 v[134:135], v13 offset:62464
    s_waitcnt lgkmcnt(7)
    v_mfma_f32_32x32x16_bf16 v[52:67], v[112:115], v[120:123], v[52:67]
    ds_read_b128 v[140:143], v183 offset:49152
    s_waitcnt lgkmcnt(6)
    v_mfma_f32_32x32x16_bf16 v[68:83], v[116:119], v[100:103], v[68:83]
    ds_read_b64_tr_b16 v[136:137], v14 offset:61440
    ds_read_b64_tr_b16 v[138:139], v14 offset:62464
    s_waitcnt lgkmcnt(8)
    v_mfma_f32_32x32x16_bf16 v[84:99], v[116:119], v[120:123], v[84:99]
    s_waitcnt lgkmcnt(5)
    v_mfma_f32_32x32x16_bf16 v[20:35], v[128:131], v[104:107], v[20:35]
    s_waitcnt vmcnt(9)
    s_barrier
    ds_read_b128 v[100:103], v8 offset:0
    ds_read_b64_tr_b16 v[108:109], v12 offset:0
    ds_read_b64_tr_b16 v[110:111], v12 offset:256
    s_waitcnt lgkmcnt(6)
    v_mfma_f32_32x32x16_bf16 v[36:51], v[132:135], v[104:107], v[36:51]
    ds_read_b64_tr_b16 v[112:113], v13 offset:0
    ds_read_b64_tr_b16 v[114:115], v13 offset:1024
    s_add_u32 m0, s58, 32768
    s_add_u32 s61, s32, 768
    buffer_load_dwordx4 v2, s[4:7], s61 offen lds
    s_waitcnt lgkmcnt(7)
    v_mfma_f32_32x32x16_bf16 v[52:67], v[132:135], v[140:143], v[52:67]
    ds_read_b128 v[120:123], v180 offset:0
    s_add_u32 m0, s58, 33792
    s_add_u32 s61, s32, 768
    buffer_load_dwordx4 v3, s[4:7], s61 offen lds
    s_waitcnt lgkmcnt(6)
    v_mfma_f32_32x32x16_bf16 v[68:83], v[136:139], v[104:107], v[68:83]
    ds_read_b64_tr_b16 v[116:117], v14 offset:0
    ds_read_b64_tr_b16 v[118:119], v14 offset:1024
    s_add_u32 m0, s58, 34816
    s_add_u32 s61, s32, 768
    buffer_load_dwordx4 v4, s[4:7], s61 offen lds
    s_waitcnt lgkmcnt(8)
    v_mfma_f32_32x32x16_bf16 v[84:99], v[136:139], v[140:143], v[84:99]
    s_add_u32 m0, s58, 35840
    s_add_u32 s61, s32, 768
    buffer_load_dwordx4 v5, s[4:7], s61 offen lds
    s_waitcnt lgkmcnt(5)
    v_mfma_f32_32x32x16_bf16 v[20:35], v[108:111], v[100:103], v[20:35]
    ds_read_b128 v[104:107], v9 offset:0
    ds_read_b64_tr_b16 v[128:129], v12 offset:1024
    ds_read_b64_tr_b16 v[130:131], v12 offset:1280
    s_add_u32 m0, s59, 8192
    s_add_u32 s61, s33, 393216
    buffer_load_dwordx4 v6, s[8:11], s61 offen lds
    s_waitcnt lgkmcnt(6)
    v_mfma_f32_32x32x16_bf16 v[36:51], v[112:115], v[100:103], v[36:51]
    ds_read_b64_tr_b16 v[132:133], v13 offset:4096
    ds_read_b64_tr_b16 v[134:135], v13 offset:5120
    s_add_u32 m0, s60, 32768
    s_add_u32 s61, s34, 1376256
    buffer_load_dwordx4 v7, s[12:15], s61 offen lds
    s_waitcnt lgkmcnt(7)
    v_mfma_f32_32x32x16_bf16 v[52:67], v[112:115], v[120:123], v[52:67]
    ds_read_b128 v[140:143], v181 offset:0
    s_add_u32 m0, s60, 33792
    s_add_u32 s61, s34, 1390592
    buffer_load_dwordx4 v7, s[12:15], s61 offen lds
    s_waitcnt lgkmcnt(6)
    v_mfma_f32_32x32x16_bf16 v[68:83], v[116:119], v[100:103], v[68:83]
    ds_read_b64_tr_b16 v[136:137], v14 offset:4096
    ds_read_b64_tr_b16 v[138:139], v14 offset:5120
    s_add_u32 m0, s60, 34816
    s_add_u32 s61, s34, 1404928
    buffer_load_dwordx4 v7, s[12:15], s61 offen lds
    s_waitcnt lgkmcnt(8)
    v_mfma_f32_32x32x16_bf16 v[84:99], v[116:119], v[120:123], v[84:99]
    s_add_u32 m0, s60, 35840
    s_add_u32 s61, s34, 1419264
    buffer_load_dwordx4 v7, s[12:15], s61 offen lds
    s_waitcnt lgkmcnt(5)
    v_mfma_f32_32x32x16_bf16 v[20:35], v[128:131], v[104:107], v[20:35]
    ds_read_b128 v[100:103], v10 offset:0
    ds_read_b64_tr_b16 v[108:109], v12 offset:2048
    ds_read_b64_tr_b16 v[110:111], v12 offset:2304
    s_waitcnt lgkmcnt(6)
    v_mfma_f32_32x32x16_bf16 v[36:51], v[132:135], v[104:107], v[36:51]
    ds_read_b64_tr_b16 v[112:113], v13 offset:8192
    ds_read_b64_tr_b16 v[114:115], v13 offset:9216
    s_waitcnt lgkmcnt(7)
    v_mfma_f32_32x32x16_bf16 v[52:67], v[132:135], v[140:143], v[52:67]
    ds_read_b128 v[120:123], v182 offset:0
    s_waitcnt lgkmcnt(6)
    v_mfma_f32_32x32x16_bf16 v[68:83], v[136:139], v[104:107], v[68:83]
    ds_read_b64_tr_b16 v[116:117], v14 offset:8192
    ds_read_b64_tr_b16 v[118:119], v14 offset:9216
    s_waitcnt lgkmcnt(8)
    v_mfma_f32_32x32x16_bf16 v[84:99], v[136:139], v[140:143], v[84:99]
    s_waitcnt lgkmcnt(5)
    v_mfma_f32_32x32x16_bf16 v[20:35], v[108:111], v[100:103], v[20:35]
    ds_read_b128 v[104:107], v11 offset:0
    ds_read_b64_tr_b16 v[128:129], v12 offset:3072
    ds_read_b64_tr_b16 v[130:131], v12 offset:3328
    s_waitcnt lgkmcnt(6)
    v_mfma_f32_32x32x16_bf16 v[36:51], v[112:115], v[100:103], v[36:51]
    ds_read_b64_tr_b16 v[132:133], v13 offset:12288
    ds_read_b64_tr_b16 v[134:135], v13 offset:13312
    s_waitcnt lgkmcnt(7)
    v_mfma_f32_32x32x16_bf16 v[52:67], v[112:115], v[120:123], v[52:67]
    ds_read_b128 v[140:143], v183 offset:0
    s_waitcnt lgkmcnt(6)
    v_mfma_f32_32x32x16_bf16 v[68:83], v[116:119], v[100:103], v[68:83]
    ds_read_b64_tr_b16 v[136:137], v14 offset:12288
    ds_read_b64_tr_b16 v[138:139], v14 offset:13312
    s_waitcnt lgkmcnt(8)
    v_mfma_f32_32x32x16_bf16 v[84:99], v[116:119], v[120:123], v[84:99]
    s_waitcnt lgkmcnt(5)
    v_mfma_f32_32x32x16_bf16 v[20:35], v[128:131], v[104:107], v[20:35]
    s_waitcnt vmcnt(9)
    s_barrier
    ds_read_b128 v[100:103], v8 offset:16384
    ds_read_b64_tr_b16 v[108:109], v12 offset:4096
    ds_read_b64_tr_b16 v[110:111], v12 offset:4352
    s_waitcnt lgkmcnt(6)
    v_mfma_f32_32x32x16_bf16 v[36:51], v[132:135], v[104:107], v[36:51]
    ds_read_b64_tr_b16 v[112:113], v13 offset:16384
    ds_read_b64_tr_b16 v[114:115], v13 offset:17408
    s_add_u32 m0, s58, 49152
    s_add_u32 s61, s32, 896
    buffer_load_dwordx4 v2, s[4:7], s61 offen lds
    s_waitcnt lgkmcnt(7)
    v_mfma_f32_32x32x16_bf16 v[52:67], v[132:135], v[140:143], v[52:67]
    ds_read_b128 v[120:123], v180 offset:16384
    s_add_u32 m0, s58, 50176
    s_add_u32 s61, s32, 896
    buffer_load_dwordx4 v3, s[4:7], s61 offen lds
    s_waitcnt lgkmcnt(6)
    v_mfma_f32_32x32x16_bf16 v[68:83], v[136:139], v[104:107], v[68:83]
    ds_read_b64_tr_b16 v[116:117], v14 offset:16384
    ds_read_b64_tr_b16 v[118:119], v14 offset:17408
    s_add_u32 m0, s58, 51200
    s_add_u32 s61, s32, 896
    buffer_load_dwordx4 v4, s[4:7], s61 offen lds
    s_waitcnt lgkmcnt(8)
    v_mfma_f32_32x32x16_bf16 v[84:99], v[136:139], v[140:143], v[84:99]
    s_add_u32 m0, s58, 52224
    s_add_u32 s61, s32, 896
    buffer_load_dwordx4 v5, s[4:7], s61 offen lds
    s_waitcnt lgkmcnt(5)
    v_mfma_f32_32x32x16_bf16 v[20:35], v[108:111], v[100:103], v[20:35]
    ds_read_b128 v[104:107], v9 offset:16384
    ds_read_b64_tr_b16 v[128:129], v12 offset:5120
    ds_read_b64_tr_b16 v[130:131], v12 offset:5376
    s_add_u32 m0, s59, 12288
    s_add_u32 s61, s33, 458752
    buffer_load_dwordx4 v6, s[8:11], s61 offen lds
    s_waitcnt lgkmcnt(6)
    v_mfma_f32_32x32x16_bf16 v[36:51], v[112:115], v[100:103], v[36:51]
    ds_read_b64_tr_b16 v[132:133], v13 offset:20480
    ds_read_b64_tr_b16 v[134:135], v13 offset:21504
    s_add_u32 m0, s60, 49152
    s_add_u32 s61, s34, 1605632
    buffer_load_dwordx4 v7, s[12:15], s61 offen lds
    s_waitcnt lgkmcnt(7)
    v_mfma_f32_32x32x16_bf16 v[52:67], v[112:115], v[120:123], v[52:67]
    ds_read_b128 v[140:143], v181 offset:16384
    s_add_u32 m0, s60, 50176
    s_add_u32 s61, s34, 1619968
    buffer_load_dwordx4 v7, s[12:15], s61 offen lds
    s_waitcnt lgkmcnt(6)
    v_mfma_f32_32x32x16_bf16 v[68:83], v[116:119], v[100:103], v[68:83]
    ds_read_b64_tr_b16 v[136:137], v14 offset:20480
    ds_read_b64_tr_b16 v[138:139], v14 offset:21504
    s_add_u32 m0, s60, 51200
    s_add_u32 s61, s34, 1634304
    buffer_load_dwordx4 v7, s[12:15], s61 offen lds
    s_waitcnt lgkmcnt(8)
    v_mfma_f32_32x32x16_bf16 v[84:99], v[116:119], v[120:123], v[84:99]
    s_add_u32 m0, s60, 52224
    s_add_u32 s61, s34, 1648640
    buffer_load_dwordx4 v7, s[12:15], s61 offen lds
    s_waitcnt lgkmcnt(5)
    v_mfma_f32_32x32x16_bf16 v[20:35], v[128:131], v[104:107], v[20:35]
    ds_read_b128 v[100:103], v10 offset:16384
    ds_read_b64_tr_b16 v[108:109], v12 offset:6144
    ds_read_b64_tr_b16 v[110:111], v12 offset:6400
    s_waitcnt lgkmcnt(6)
    v_mfma_f32_32x32x16_bf16 v[36:51], v[132:135], v[104:107], v[36:51]
    ds_read_b64_tr_b16 v[112:113], v13 offset:24576
    ds_read_b64_tr_b16 v[114:115], v13 offset:25600
    s_waitcnt lgkmcnt(7)
    v_mfma_f32_32x32x16_bf16 v[52:67], v[132:135], v[140:143], v[52:67]
    ds_read_b128 v[120:123], v182 offset:16384
    s_waitcnt lgkmcnt(6)
    v_mfma_f32_32x32x16_bf16 v[68:83], v[136:139], v[104:107], v[68:83]
    ds_read_b64_tr_b16 v[116:117], v14 offset:24576
    ds_read_b64_tr_b16 v[118:119], v14 offset:25600
    s_waitcnt lgkmcnt(8)
    v_mfma_f32_32x32x16_bf16 v[84:99], v[136:139], v[140:143], v[84:99]
    s_waitcnt lgkmcnt(5)
    v_mfma_f32_32x32x16_bf16 v[20:35], v[108:111], v[100:103], v[20:35]
    ds_read_b128 v[104:107], v11 offset:16384
    ds_read_b64_tr_b16 v[128:129], v12 offset:7168
    ds_read_b64_tr_b16 v[130:131], v12 offset:7424
    s_waitcnt lgkmcnt(6)
    v_mfma_f32_32x32x16_bf16 v[36:51], v[112:115], v[100:103], v[36:51]
    ds_read_b64_tr_b16 v[132:133], v13 offset:28672
    ds_read_b64_tr_b16 v[134:135], v13 offset:29696
    s_waitcnt lgkmcnt(7)
    v_mfma_f32_32x32x16_bf16 v[52:67], v[112:115], v[120:123], v[52:67]
    ds_read_b128 v[140:143], v183 offset:16384
    s_waitcnt lgkmcnt(6)
    v_mfma_f32_32x32x16_bf16 v[68:83], v[116:119], v[100:103], v[68:83]
    ds_read_b64_tr_b16 v[136:137], v14 offset:28672
    ds_read_b64_tr_b16 v[138:139], v14 offset:29696
    s_waitcnt lgkmcnt(8)
    v_mfma_f32_32x32x16_bf16 v[84:99], v[116:119], v[120:123], v[84:99]
    s_waitcnt lgkmcnt(5)
    v_mfma_f32_32x32x16_bf16 v[20:35], v[128:131], v[104:107], v[20:35]
    s_waitcnt vmcnt(9)
    s_barrier
    ds_read_b128 v[100:103], v8 offset:32768
    ds_read_b64_tr_b16 v[108:109], v12 offset:8192
    ds_read_b64_tr_b16 v[110:111], v12 offset:8448
    s_waitcnt lgkmcnt(6)
    v_mfma_f32_32x32x16_bf16 v[36:51], v[132:135], v[104:107], v[36:51]
    ds_read_b64_tr_b16 v[112:113], v13 offset:32768
    ds_read_b64_tr_b16 v[114:115], v13 offset:33792
    s_waitcnt lgkmcnt(7)
    v_mfma_f32_32x32x16_bf16 v[52:67], v[132:135], v[140:143], v[52:67]
    ds_read_b128 v[120:123], v180 offset:32768
    s_waitcnt lgkmcnt(6)
    v_mfma_f32_32x32x16_bf16 v[68:83], v[136:139], v[104:107], v[68:83]
    ds_read_b64_tr_b16 v[116:117], v14 offset:32768
    ds_read_b64_tr_b16 v[118:119], v14 offset:33792
    s_waitcnt lgkmcnt(8)
    v_mfma_f32_32x32x16_bf16 v[84:99], v[136:139], v[140:143], v[84:99]
    s_waitcnt lgkmcnt(5)
    v_mfma_f32_32x32x16_bf16 v[20:35], v[108:111], v[100:103], v[20:35]
    ds_read_b128 v[104:107], v9 offset:32768
    ds_read_b64_tr_b16 v[128:129], v12 offset:9216
    ds_read_b64_tr_b16 v[130:131], v12 offset:9472
    s_waitcnt lgkmcnt(6)
    v_mfma_f32_32x32x16_bf16 v[36:51], v[112:115], v[100:103], v[36:51]
    ds_read_b64_tr_b16 v[132:133], v13 offset:36864
    ds_read_b64_tr_b16 v[134:135], v13 offset:37888
    s_waitcnt lgkmcnt(7)
    v_mfma_f32_32x32x16_bf16 v[52:67], v[112:115], v[120:123], v[52:67]
    ds_read_b128 v[140:143], v181 offset:32768
    s_waitcnt lgkmcnt(6)
    v_mfma_f32_32x32x16_bf16 v[68:83], v[116:119], v[100:103], v[68:83]
    ds_read_b64_tr_b16 v[136:137], v14 offset:36864
    ds_read_b64_tr_b16 v[138:139], v14 offset:37888
    s_waitcnt lgkmcnt(8)
    v_mfma_f32_32x32x16_bf16 v[84:99], v[116:119], v[120:123], v[84:99]
    s_waitcnt lgkmcnt(5)
    v_mfma_f32_32x32x16_bf16 v[20:35], v[128:131], v[104:107], v[20:35]
    ds_read_b128 v[100:103], v10 offset:32768
    ds_read_b64_tr_b16 v[108:109], v12 offset:10240
    ds_read_b64_tr_b16 v[110:111], v12 offset:10496
    s_waitcnt lgkmcnt(6)
    v_mfma_f32_32x32x16_bf16 v[36:51], v[132:135], v[104:107], v[36:51]
    ds_read_b64_tr_b16 v[112:113], v13 offset:40960
    ds_read_b64_tr_b16 v[114:115], v13 offset:41984
    s_waitcnt lgkmcnt(7)
    v_mfma_f32_32x32x16_bf16 v[52:67], v[132:135], v[140:143], v[52:67]
    ds_read_b128 v[120:123], v182 offset:32768
    s_waitcnt lgkmcnt(6)
    v_mfma_f32_32x32x16_bf16 v[68:83], v[136:139], v[104:107], v[68:83]
    ds_read_b64_tr_b16 v[116:117], v14 offset:40960
    ds_read_b64_tr_b16 v[118:119], v14 offset:41984
    s_waitcnt lgkmcnt(8)
    v_mfma_f32_32x32x16_bf16 v[84:99], v[136:139], v[140:143], v[84:99]
    s_waitcnt lgkmcnt(5)
    v_mfma_f32_32x32x16_bf16 v[20:35], v[108:111], v[100:103], v[20:35]
    ds_read_b128 v[104:107], v11 offset:32768
    ds_read_b64_tr_b16 v[128:129], v12 offset:11264
    ds_read_b64_tr_b16 v[130:131], v12 offset:11520
    s_waitcnt lgkmcnt(6)
    v_mfma_f32_32x32x16_bf16 v[36:51], v[112:115], v[100:103], v[36:51]
    ds_read_b64_tr_b16 v[132:133], v13 offset:45056
    ds_read_b64_tr_b16 v[134:135], v13 offset:46080
    s_waitcnt lgkmcnt(7)
    v_mfma_f32_32x32x16_bf16 v[52:67], v[112:115], v[120:123], v[52:67]
    ds_read_b128 v[140:143], v183 offset:32768
    s_waitcnt lgkmcnt(6)
    v_mfma_f32_32x32x16_bf16 v[68:83], v[116:119], v[100:103], v[68:83]
    ds_read_b64_tr_b16 v[136:137], v14 offset:45056
    ds_read_b64_tr_b16 v[138:139], v14 offset:46080
    s_waitcnt lgkmcnt(8)
    v_mfma_f32_32x32x16_bf16 v[84:99], v[116:119], v[120:123], v[84:99]
    s_waitcnt lgkmcnt(5)
    v_mfma_f32_32x32x16_bf16 v[20:35], v[128:131], v[104:107], v[20:35]
    s_waitcnt vmcnt(0)
    s_barrier
    s_lshl_b32 s68, s2, 13
    s_lshl_b32 s69, s28, 11
    s_add_u32 s68, s68, s69
    s_add_u32 s68, s68, 2097152
    v_lshlrev_b32 v195, 4, v1
    v_mov_b32 v196, -1
    v_mov_b32 v197, -1
    v_mov_b32 v198, -1
    v_mov_b32 v199, -1
    buffer_store_dwordx4 v[196:199], v195, s[16:19], s68 offen
    buffer_store_dwordx4 v[196:199], v195, s[16:19], s68 offen offset:1024
    ds_read_b128 v[100:103], v8 offset:49152
    ds_read_b64_tr_b16 v[108:109], v12 offset:12288
    ds_read_b64_tr_b16 v[110:111], v12 offset:12544
    s_waitcnt lgkmcnt(6)
    v_mfma_f32_32x32x16_bf16 v[36:51], v[132:135], v[104:107], v[36:51]
    ds_read_b64_tr_b16 v[112:113], v13 offset:49152
    ds_read_b64_tr_b16 v[114:115], v13 offset:50176
    s_waitcnt lgkmcnt(7)
    v_mfma_f32_32x32x16_bf16 v[52:67], v[132:135], v[140:143], v[52:67]
    ds_read_b128 v[120:123], v180 offset:49152
    s_waitcnt lgkmcnt(6)
    v_mfma_f32_32x32x16_bf16 v[68:83], v[136:139], v[104:107], v[68:83]
    ds_read_b64_tr_b16 v[116:117], v14 offset:49152
    ds_read_b64_tr_b16 v[118:119], v14 offset:50176
    s_waitcnt lgkmcnt(8)
    v_mfma_f32_32x32x16_bf16 v[84:99], v[136:139], v[140:143], v[84:99]
    s_waitcnt lgkmcnt(5)
    v_mfma_f32_32x32x16_bf16 v[20:35], v[108:111], v[100:103], v[20:35]
    ds_read_b128 v[104:107], v9 offset:49152
    ds_read_b64_tr_b16 v[128:129], v12 offset:13312
    ds_read_b64_tr_b16 v[130:131], v12 offset:13568
    s_waitcnt lgkmcnt(6)
    v_mfma_f32_32x32x16_bf16 v[36:51], v[112:115], v[100:103], v[36:51]
    ds_read_b64_tr_b16 v[132:133], v13 offset:53248
    ds_read_b64_tr_b16 v[134:135], v13 offset:54272
    s_waitcnt lgkmcnt(7)
    v_mfma_f32_32x32x16_bf16 v[52:67], v[112:115], v[120:123], v[52:67]
    ds_read_b128 v[140:143], v181 offset:49152
    s_waitcnt lgkmcnt(6)
    v_mfma_f32_32x32x16_bf16 v[68:83], v[116:119], v[100:103], v[68:83]
    ds_read_b64_tr_b16 v[136:137], v14 offset:53248
    ds_read_b64_tr_b16 v[138:139], v14 offset:54272
    s_waitcnt lgkmcnt(8)
    v_mfma_f32_32x32x16_bf16 v[84:99], v[116:119], v[120:123], v[84:99]
    s_waitcnt lgkmcnt(5)
    v_mfma_f32_32x32x16_bf16 v[20:35], v[128:131], v[104:107], v[20:35]
    ds_read_b128 v[100:103], v10 offset:49152
    ds_read_b64_tr_b16 v[108:109], v12 offset:14336
    ds_read_b64_tr_b16 v[110:111], v12 offset:14592
    s_waitcnt lgkmcnt(6)
    v_mfma_f32_32x32x16_bf16 v[36:51], v[132:135], v[104:107], v[36:51]
    ds_read_b64_tr_b16 v[112:113], v13 offset:57344
    ds_read_b64_tr_b16 v[114:115], v13 offset:58368
    s_waitcnt lgkmcnt(7)
    v_mfma_f32_32x32x16_bf16 v[52:67], v[132:135], v[140:143], v[52:67]
    ds_read_b128 v[120:123], v182 offset:49152
    s_waitcnt lgkmcnt(6)
    v_mfma_f32_32x32x16_bf16 v[68:83], v[136:139], v[104:107], v[68:83]
    ds_read_b64_tr_b16 v[116:117], v14 offset:57344
    ds_read_b64_tr_b16 v[118:119], v14 offset:58368
    s_waitcnt lgkmcnt(8)
    v_mfma_f32_32x32x16_bf16 v[84:99], v[136:139], v[140:143], v[84:99]
    s_waitcnt lgkmcnt(5)
    v_mfma_f32_32x32x16_bf16 v[20:35], v[108:111], v[100:103], v[20:35]
    ds_read_b128 v[104:107], v11 offset:49152
    ds_read_b64_tr_b16 v[128:129], v12 offset:15360
    ds_read_b64_tr_b16 v[130:131], v12 offset:15616
    s_waitcnt lgkmcnt(6)
    v_mfma_f32_32x32x16_bf16 v[36:51], v[112:115], v[100:103], v[36:51]
    ds_read_b64_tr_b16 v[132:133], v13 offset:61440
    ds_read_b64_tr_b16 v[134:135], v13 offset:62464
    s_waitcnt lgkmcnt(7)
    v_mfma_f32_32x32x16_bf16 v[52:67], v[112:115], v[120:123], v[52:67]
    ds_read_b128 v[140:143], v183 offset:49152
    s_waitcnt lgkmcnt(6)
    v_mfma_f32_32x32x16_bf16 v[68:83], v[116:119], v[100:103], v[68:83]
    ds_read_b64_tr_b16 v[136:137], v14 offset:61440
    ds_read_b64_tr_b16 v[138:139], v14 offset:62464
    s_waitcnt lgkmcnt(8)
    v_mfma_f32_32x32x16_bf16 v[84:99], v[116:119], v[120:123], v[84:99]
    s_waitcnt lgkmcnt(5)
    v_mfma_f32_32x32x16_bf16 v[20:35], v[128:131], v[104:107], v[20:35]
    s_waitcnt lgkmcnt(3)
    v_mfma_f32_32x32x16_bf16 v[36:51], v[132:135], v[104:107], v[36:51]
    s_waitcnt lgkmcnt(2)
    v_mfma_f32_32x32x16_bf16 v[52:67], v[132:135], v[140:143], v[52:67]
    s_waitcnt lgkmcnt(0)
    v_mfma_f32_32x32x16_bf16 v[68:83], v[136:139], v[104:107], v[68:83]
    s_waitcnt lgkmcnt(0)
    v_mfma_f32_32x32x16_bf16 v[84:99], v[136:139], v[140:143], v[84:99]
    s_nop 7
    s_nop 7
    v_lshlrev_b32 v17, 4, v1
    s_mov_b32 s64, 0x3fb8aa3b
    s_mov_b32 s65, 0x3eb8aa3b
    s_lshl_b32 s62, s31, 15
    s_lshl_b32 s35, s30, 11
    s_add_u32 s62, s62, s35
    v_mul_f32 v20, s65, v20
    v_mul_f32 v21, s65, v21
    v_mul_f32 v22, s65, v22
    v_mul_f32 v23, s65, v23
    v_mul_f32 v24, s65, v24
    v_mul_f32 v25, s65, v25
    v_mul_f32 v26, s65, v26
    v_mul_f32 v27, s65, v27
    v_mul_f32 v28, s65, v28
    v_mul_f32 v29, s65, v29
    v_mul_f32 v30, s65, v30
    v_mul_f32 v31, s65, v31
    v_mul_f32 v32, s65, v32
    v_mul_f32 v33, s65, v33
    v_mul_f32 v34, s65, v34
    v_mul_f32 v35, s65, v35
    v_cvt_pk_bf16_f32 v148, v20, v21
    v_cvt_pk_bf16_f32 v149, v22, v23
    v_cvt_pk_bf16_f32 v150, v24, v25
    v_cvt_pk_bf16_f32 v151, v26, v27
    v_cvt_pk_bf16_f32 v152, v28, v29
    v_cvt_pk_bf16_f32 v153, v30, v31
    v_cvt_pk_bf16_f32 v154, v32, v33
    v_cvt_pk_bf16_f32 v155, v34, v35
    buffer_store_dwordx4 v[148:151], v17, s[16:19], s62 offen offset:0
    buffer_store_dwordx4 v[152:155], v17, s[16:19], s62 offen offset:1024
    s_mul_i32 s63, s31, 114688
    s_lshl_b32 s35, s30, 13
    s_add_u32 s63, s63, s35
    s_add_u32 s63, s63, 6291456
    s_and_b32 s35, s28, 1
    s_lshl_b32 s61, s35, 12
    s_add_u32 s63, s63, s61
    s_mul_i32 s35, s35, 229376
    s_add_u32 s61, s63, 114688
    s_sub_u32 s61, s61, s35
    s_mov_b32 s52, 0x3fb8aa3b
    s_mov_b32 s53, 0x3fb8aa3b
    s_mov_b32 s54, 0x40000000
    s_mov_b32 s55, 0x40000000
    s_mov_b32 s50, 0xc0000000
    s_mov_b32 s51, 0xc0000000
    v_pk_mul_f32 v[156:157], v[36:37], s[52:53]
    v_pk_mul_f32 v[158:159], v[38:39], s[52:53]
    v_pk_mul_f32 v[160:161], v[40:41], s[52:53]
    v_pk_mul_f32 v[162:163], v[42:43], s[52:53]
    v_exp_f32 v156, v156
    v_exp_f32 v157, v157
    v_exp_f32 v158, v158
    v_exp_f32 v159, v159
    v_exp_f32 v160, v160
    v_exp_f32 v161, v161
    v_exp_f32 v162, v162
    v_exp_f32 v163, v163
    v_pk_add_f32 v[164:165], v[156:157], s[54:55]
    v_pk_add_f32 v[166:167], v[158:159], s[54:55]
    v_pk_add_f32 v[168:169], v[160:161], s[54:55]
    v_pk_add_f32 v[170:171], v[162:163], s[54:55]
    v_pk_fma_f32 v[164:165], v[156:157], v[164:165], s[54:55]
    v_pk_fma_f32 v[166:167], v[158:159], v[166:167], s[54:55]
    v_pk_fma_f32 v[168:169], v[160:161], v[168:169], s[54:55]
    v_pk_fma_f32 v[170:171], v[162:163], v[170:171], s[54:55]
    v_rcp_f32 v164, v164
    v_rcp_f32 v165, v165
    v_rcp_f32 v166, v166
    v_rcp_f32 v167, v167
    v_rcp_f32 v168, v168
    v_rcp_f32 v169, v169
    v_rcp_f32 v170, v170
    v_rcp_f32 v171, v171
    v_pk_mul_f32 v[164:165], v[36:37], v[164:165]
    v_pk_mul_f32 v[166:167], v[38:39], v[166:167]
    v_pk_mul_f32 v[168:169], v[40:41], v[168:169]
    v_pk_mul_f32 v[170:171], v[42:43], v[170:171]
    v_pk_fma_f32 v[36:37], v[164:165], s[50:51], v[36:37]
    v_pk_fma_f32 v[38:39], v[166:167], s[50:51], v[38:39]
    v_pk_fma_f32 v[40:41], v[168:169], s[50:51], v[40:41]
    v_pk_fma_f32 v[42:43], v[170:171], s[50:51], v[42:43]
    v_cvt_pk_bf16_f32 v172, v36, v37
    v_cvt_pk_bf16_f32 v173, v38, v39
    v_cvt_pk_bf16_f32 v174, v40, v41
    v_cvt_pk_bf16_f32 v175, v42, v43
    v_pk_mul_f32 v[156:157], v[44:45], s[52:53]
    v_pk_mul_f32 v[158:159], v[46:47], s[52:53]
    v_pk_mul_f32 v[160:161], v[48:49], s[52:53]
    v_pk_mul_f32 v[162:163], v[50:51], s[52:53]
    v_exp_f32 v156, v156
    v_exp_f32 v157, v157
    v_exp_f32 v158, v158
    v_exp_f32 v159, v159
    v_exp_f32 v160, v160
    v_exp_f32 v161, v161
    v_exp_f32 v162, v162
    v_exp_f32 v163, v163
    v_pk_add_f32 v[164:165], v[156:157], s[54:55]
    v_pk_add_f32 v[166:167], v[158:159], s[54:55]
    v_pk_add_f32 v[168:169], v[160:161], s[54:55]
    v_pk_add_f32 v[170:171], v[162:163], s[54:55]
    v_pk_fma_f32 v[164:165], v[156:157], v[164:165], s[54:55]
    v_pk_fma_f32 v[166:167], v[158:159], v[166:167], s[54:55]
    v_pk_fma_f32 v[168:169], v[160:161], v[168:169], s[54:55]
    v_pk_fma_f32 v[170:171], v[162:163], v[170:171], s[54:55]
    v_rcp_f32 v164, v164
    v_rcp_f32 v165, v165
    v_rcp_f32 v166, v166
    v_rcp_f32 v167, v167
    v_rcp_f32 v168, v168
    v_rcp_f32 v169, v169
    v_rcp_f32 v170, v170
    v_rcp_f32 v171, v171
    v_pk_mul_f32 v[164:165], v[44:45], v[164:165]
    v_pk_mul_f32 v[166:167], v[46:47], v[166:167]
    v_pk_mul_f32 v[168:169], v[48:49], v[168:169]
    v_pk_mul_f32 v[170:171], v[50:51], v[170:171]
    v_pk_fma_f32 v[44:45], v[164:165], s[50:51], v[44:45]
    v_pk_fma_f32 v[46:47], v[166:167], s[50:51], v[46:47]
    v_pk_fma_f32 v[48:49], v[168:169], s[50:51], v[48:49]
    v_pk_fma_f32 v[50:51], v[170:171], s[50:51], v[50:51]
    v_cvt_pk_bf16_f32 v176, v44, v45
    v_cvt_pk_bf16_f32 v177, v46, v47
    v_cvt_pk_bf16_f32 v178, v48, v49
    v_cvt_pk_bf16_f32 v179, v50, v51
    buffer_store_dwordx4 v[172:175], v17, s[16:19], s63 offen offset:0
    buffer_store_dwordx4 v[176:179], v17, s[16:19], s63 offen offset:1024
    v_pk_mul_f32 v[156:157], v[52:53], s[52:53]
    v_pk_mul_f32 v[158:159], v[54:55], s[52:53]
    v_pk_mul_f32 v[160:161], v[56:57], s[52:53]
    v_pk_mul_f32 v[162:163], v[58:59], s[52:53]
    v_exp_f32 v156, v156
    v_exp_f32 v157, v157
    v_exp_f32 v158, v158
    v_exp_f32 v159, v159
    v_exp_f32 v160, v160
    v_exp_f32 v161, v161
    v_exp_f32 v162, v162
    v_exp_f32 v163, v163
    v_pk_add_f32 v[164:165], v[156:157], s[54:55]
    v_pk_add_f32 v[166:167], v[158:159], s[54:55]
    v_pk_add_f32 v[168:169], v[160:161], s[54:55]
    v_pk_add_f32 v[170:171], v[162:163], s[54:55]
    v_pk_fma_f32 v[164:165], v[156:157], v[164:165], s[54:55]
    v_pk_fma_f32 v[166:167], v[158:159], v[166:167], s[54:55]
    v_pk_fma_f32 v[168:169], v[160:161], v[168:169], s[54:55]
    v_pk_fma_f32 v[170:171], v[162:163], v[170:171], s[54:55]
    v_rcp_f32 v164, v164
    v_rcp_f32 v165, v165
    v_rcp_f32 v166, v166
    v_rcp_f32 v167, v167
    v_rcp_f32 v168, v168
    v_rcp_f32 v169, v169
    v_rcp_f32 v170, v170
    v_rcp_f32 v171, v171
    v_pk_mul_f32 v[164:165], v[52:53], v[164:165]
    v_pk_mul_f32 v[166:167], v[54:55], v[166:167]
    v_pk_mul_f32 v[168:169], v[56:57], v[168:169]
    v_pk_mul_f32 v[170:171], v[58:59], v[170:171]
    v_pk_fma_f32 v[52:53], v[164:165], s[50:51], v[52:53]
    v_pk_fma_f32 v[54:55], v[166:167], s[50:51], v[54:55]
    v_pk_fma_f32 v[56:57], v[168:169], s[50:51], v[56:57]
    v_pk_fma_f32 v[58:59], v[170:171], s[50:51], v[58:59]
    v_cvt_pk_bf16_f32 v180, v52, v53
    v_cvt_pk_bf16_f32 v181, v54, v55
    v_cvt_pk_bf16_f32 v182, v56, v57
    v_cvt_pk_bf16_f32 v183, v58, v59
    v_pk_mul_f32 v[156:157], v[60:61], s[52:53]
    v_pk_mul_f32 v[158:159], v[62:63], s[52:53]
    v_pk_mul_f32 v[160:161], v[64:65], s[52:53]
    v_pk_mul_f32 v[162:163], v[66:67], s[52:53]
    v_exp_f32 v156, v156
    v_exp_f32 v157, v157
    v_exp_f32 v158, v158
    v_exp_f32 v159, v159
    v_exp_f32 v160, v160
    v_exp_f32 v161, v161
    v_exp_f32 v162, v162
    v_exp_f32 v163, v163
    v_pk_add_f32 v[164:165], v[156:157], s[54:55]
    v_pk_add_f32 v[166:167], v[158:159], s[54:55]
    v_pk_add_f32 v[168:169], v[160:161], s[54:55]
    v_pk_add_f32 v[170:171], v[162:163], s[54:55]
    v_pk_fma_f32 v[164:165], v[156:157], v[164:165], s[54:55]
    v_pk_fma_f32 v[166:167], v[158:159], v[166:167], s[54:55]
    v_pk_fma_f32 v[168:169], v[160:161], v[168:169], s[54:55]
    v_pk_fma_f32 v[170:171], v[162:163], v[170:171], s[54:55]
    v_rcp_f32 v164, v164
    v_rcp_f32 v165, v165
    v_rcp_f32 v166, v166
    v_rcp_f32 v167, v167
    v_rcp_f32 v168, v168
    v_rcp_f32 v169, v169
    v_rcp_f32 v170, v170
    v_rcp_f32 v171, v171
    v_pk_mul_f32 v[164:165], v[60:61], v[164:165]
    v_pk_mul_f32 v[166:167], v[62:63], v[166:167]
    v_pk_mul_f32 v[168:169], v[64:65], v[168:169]
    v_pk_mul_f32 v[170:171], v[66:67], v[170:171]
    v_pk_fma_f32 v[60:61], v[164:165], s[50:51], v[60:61]
    v_pk_fma_f32 v[62:63], v[166:167], s[50:51], v[62:63]
    v_pk_fma_f32 v[64:65], v[168:169], s[50:51], v[64:65]
    v_pk_fma_f32 v[66:67], v[170:171], s[50:51], v[66:67]
    v_cvt_pk_bf16_f32 v184, v60, v61
    v_cvt_pk_bf16_f32 v185, v62, v63
    v_cvt_pk_bf16_f32 v186, v64, v65
    v_cvt_pk_bf16_f32 v187, v66, v67
    buffer_store_dwordx4 v[180:183], v17, s[16:19], s61 offen offset:0
    buffer_store_dwordx4 v[184:187], v17, s[16:19], s61 offen offset:1024
    v_pk_mul_f32 v[156:157], v[68:69], s[52:53]
    v_pk_mul_f32 v[158:159], v[70:71], s[52:53]
    v_pk_mul_f32 v[160:161], v[72:73], s[52:53]
    v_pk_mul_f32 v[162:163], v[74:75], s[52:53]
    v_exp_f32 v156, v156
    v_exp_f32 v157, v157
    v_exp_f32 v158, v158
    v_exp_f32 v159, v159
    v_exp_f32 v160, v160
    v_exp_f32 v161, v161
    v_exp_f32 v162, v162
    v_exp_f32 v163, v163
    v_pk_add_f32 v[164:165], v[156:157], s[54:55]
    v_pk_add_f32 v[166:167], v[158:159], s[54:55]
    v_pk_add_f32 v[168:169], v[160:161], s[54:55]
    v_pk_add_f32 v[170:171], v[162:163], s[54:55]
    v_pk_fma_f32 v[164:165], v[156:157], v[164:165], s[54:55]
    v_pk_fma_f32 v[166:167], v[158:159], v[166:167], s[54:55]
    v_pk_fma_f32 v[168:169], v[160:161], v[168:169], s[54:55]
    v_pk_fma_f32 v[170:171], v[162:163], v[170:171], s[54:55]
    v_rcp_f32 v164, v164
    v_rcp_f32 v165, v165
    v_rcp_f32 v166, v166
    v_rcp_f32 v167, v167
    v_rcp_f32 v168, v168
    v_rcp_f32 v169, v169
    v_rcp_f32 v170, v170
    v_rcp_f32 v171, v171
    v_pk_mul_f32 v[164:165], v[68:69], v[164:165]
    v_pk_mul_f32 v[166:167], v[70:71], v[166:167]
    v_pk_mul_f32 v[168:169], v[72:73], v[168:169]
    v_pk_mul_f32 v[170:171], v[74:75], v[170:171]
    v_pk_fma_f32 v[68:69], v[164:165], s[50:51], v[68:69]
    v_pk_fma_f32 v[70:71], v[166:167], s[50:51], v[70:71]
    v_pk_fma_f32 v[72:73], v[168:169], s[50:51], v[72:73]
    v_pk_fma_f32 v[74:75], v[170:171], s[50:51], v[74:75]
    v_cvt_pk_bf16_f32 v172, v68, v69
    v_cvt_pk_bf16_f32 v173, v70, v71
    v_cvt_pk_bf16_f32 v174, v72, v73
    v_cvt_pk_bf16_f32 v175, v74, v75
    v_pk_mul_f32 v[156:157], v[76:77], s[52:53]
    v_pk_mul_f32 v[158:159], v[78:79], s[52:53]
    v_pk_mul_f32 v[160:161], v[80:81], s[52:53]
    v_pk_mul_f32 v[162:163], v[82:83], s[52:53]
    v_exp_f32 v156, v156
    v_exp_f32 v157, v157
    v_exp_f32 v158, v158
    v_exp_f32 v159, v159
    v_exp_f32 v160, v160
    v_exp_f32 v161, v161
    v_exp_f32 v162, v162
    v_exp_f32 v163, v163
    v_pk_add_f32 v[164:165], v[156:157], s[54:55]
    v_pk_add_f32 v[166:167], v[158:159], s[54:55]
    v_pk_add_f32 v[168:169], v[160:161], s[54:55]
    v_pk_add_f32 v[170:171], v[162:163], s[54:55]
    v_pk_fma_f32 v[164:165], v[156:157], v[164:165], s[54:55]
    v_pk_fma_f32 v[166:167], v[158:159], v[166:167], s[54:55]
    v_pk_fma_f32 v[168:169], v[160:161], v[168:169], s[54:55]
    v_pk_fma_f32 v[170:171], v[162:163], v[170:171], s[54:55]
    v_rcp_f32 v164, v164
    v_rcp_f32 v165, v165
    v_rcp_f32 v166, v166
    v_rcp_f32 v167, v167
    v_rcp_f32 v168, v168
    v_rcp_f32 v169, v169
    v_rcp_f32 v170, v170
    v_rcp_f32 v171, v171
    v_pk_mul_f32 v[164:165], v[76:77], v[164:165]
    v_pk_mul_f32 v[166:167], v[78:79], v[166:167]
    v_pk_mul_f32 v[168:169], v[80:81], v[168:169]
    v_pk_mul_f32 v[170:171], v[82:83], v[170:171]
    v_pk_fma_f32 v[76:77], v[164:165], s[50:51], v[76:77]
    v_pk_fma_f32 v[78:79], v[166:167], s[50:51], v[78:79]
    v_pk_fma_f32 v[80:81], v[168:169], s[50:51], v[80:81]
    v_pk_fma_f32 v[82:83], v[170:171], s[50:51], v[82:83]
    v_cvt_pk_bf16_f32 v176, v76, v77
    v_cvt_pk_bf16_f32 v177, v78, v79
    v_cvt_pk_bf16_f32 v178, v80, v81
    v_cvt_pk_bf16_f32 v179, v82, v83
    buffer_store_dwordx4 v[172:175], v17, s[16:19], s63 offen offset:2048
    buffer_store_dwordx4 v[176:179], v17, s[16:19], s63 offen offset:3072
    v_pk_mul_f32 v[156:157], v[84:85], s[52:53]
    v_pk_mul_f32 v[158:159], v[86:87], s[52:53]
    v_pk_mul_f32 v[160:161], v[88:89], s[52:53]
    v_pk_mul_f32 v[162:163], v[90:91], s[52:53]
    v_exp_f32 v156, v156
    v_exp_f32 v157, v157
    v_exp_f32 v158, v158
    v_exp_f32 v159, v159
    v_exp_f32 v160, v160
    v_exp_f32 v161, v161
    v_exp_f32 v162, v162
    v_exp_f32 v163, v163
    v_pk_add_f32 v[164:165], v[156:157], s[54:55]
    v_pk_add_f32 v[166:167], v[158:159], s[54:55]
    v_pk_add_f32 v[168:169], v[160:161], s[54:55]
    v_pk_add_f32 v[170:171], v[162:163], s[54:55]
    v_pk_fma_f32 v[164:165], v[156:157], v[164:165], s[54:55]
    v_pk_fma_f32 v[166:167], v[158:159], v[166:167], s[54:55]
    v_pk_fma_f32 v[168:169], v[160:161], v[168:169], s[54:55]
    v_pk_fma_f32 v[170:171], v[162:163], v[170:171], s[54:55]
    v_rcp_f32 v164, v164
    v_rcp_f32 v165, v165
    v_rcp_f32 v166, v166
    v_rcp_f32 v167, v167
    v_rcp_f32 v168, v168
    v_rcp_f32 v169, v169
    v_rcp_f32 v170, v170
    v_rcp_f32 v171, v171
    v_pk_mul_f32 v[164:165], v[84:85], v[164:165]
    v_pk_mul_f32 v[166:167], v[86:87], v[166:167]
    v_pk_mul_f32 v[168:169], v[88:89], v[168:169]
    v_pk_mul_f32 v[170:171], v[90:91], v[170:171]
    v_pk_fma_f32 v[84:85], v[164:165], s[50:51], v[84:85]
    v_pk_fma_f32 v[86:87], v[166:167], s[50:51], v[86:87]
    v_pk_fma_f32 v[88:89], v[168:169], s[50:51], v[88:89]
    v_pk_fma_f32 v[90:91], v[170:171], s[50:51], v[90:91]
    v_cvt_pk_bf16_f32 v180, v84, v85
    v_cvt_pk_bf16_f32 v181, v86, v87
    v_cvt_pk_bf16_f32 v182, v88, v89
    v_cvt_pk_bf16_f32 v183, v90, v91
    v_pk_mul_f32 v[156:157], v[92:93], s[52:53]
    v_pk_mul_f32 v[158:159], v[94:95], s[52:53]
    v_pk_mul_f32 v[160:161], v[96:97], s[52:53]
    v_pk_mul_f32 v[162:163], v[98:99], s[52:53]
    v_exp_f32 v156, v156
    v_exp_f32 v157, v157
    v_exp_f32 v158, v158
    v_exp_f32 v159, v159
    v_exp_f32 v160, v160
    v_exp_f32 v161, v161
    v_exp_f32 v162, v162
    v_exp_f32 v163, v163
    v_pk_add_f32 v[164:165], v[156:157], s[54:55]
    v_pk_add_f32 v[166:167], v[158:159], s[54:55]
    v_pk_add_f32 v[168:169], v[160:161], s[54:55]
    v_pk_add_f32 v[170:171], v[162:163], s[54:55]
    v_pk_fma_f32 v[164:165], v[156:157], v[164:165], s[54:55]
    v_pk_fma_f32 v[166:167], v[158:159], v[166:167], s[54:55]
    v_pk_fma_f32 v[168:169], v[160:161], v[168:169], s[54:55]
    v_pk_fma_f32 v[170:171], v[162:163], v[170:171], s[54:55]
    v_rcp_f32 v164, v164
    v_rcp_f32 v165, v165
    v_rcp_f32 v166, v166
    v_rcp_f32 v167, v167
    v_rcp_f32 v168, v168
    v_rcp_f32 v169, v169
    v_rcp_f32 v170, v170
    v_rcp_f32 v171, v171
    v_pk_mul_f32 v[164:165], v[92:93], v[164:165]
    v_pk_mul_f32 v[166:167], v[94:95], v[166:167]
    v_pk_mul_f32 v[168:169], v[96:97], v[168:169]
    v_pk_mul_f32 v[170:171], v[98:99], v[170:171]
    v_pk_fma_f32 v[92:93], v[164:165], s[50:51], v[92:93]
    v_pk_fma_f32 v[94:95], v[166:167], s[50:51], v[94:95]
    v_pk_fma_f32 v[96:97], v[168:169], s[50:51], v[96:97]
    v_pk_fma_f32 v[98:99], v[170:171], s[50:51], v[98:99]
    v_cvt_pk_bf16_f32 v184, v92, v93
    v_cvt_pk_bf16_f32 v185, v94, v95
    v_cvt_pk_bf16_f32 v186, v96, v97
    v_cvt_pk_bf16_f32 v187, v98, v99
    buffer_store_dwordx4 v[180:183], v17, s[16:19], s61 offen offset:2048
    buffer_store_dwordx4 v[184:187], v17, s[16:19], s61 offen offset:3072
    s_endpgm
L_k1_special:
    v_lshrrev_b32 v17, 3, v1
    v_lshrrev_b32 v18, 4, v1
    v_and_b32 v19, 7, v1
    v_add_u32 v2, 0, v18
    v_xor_b32 v2, v2, v19
    v_lshlrev_b32 v2, 4, v2
    v_add_u32 v148, 0, v17
    v_lshlrev_b32 v148, 10, v148
    v_add_u32 v2, v2, v148
    v_add_u32 v3, 4, v18
    v_xor_b32 v3, v3, v19
    v_lshlrev_b32 v3, 4, v3
    v_add_u32 v148, 8, v17
    v_lshlrev_b32 v148, 10, v148
    v_add_u32 v3, v3, v148
    v_add_u32 v4, 0, v18
    v_xor_b32 v4, v4, v19
    v_lshlrev_b32 v4, 4, v4
    v_add_u32 v148, 16, v17
    v_lshlrev_b32 v148, 10, v148
    v_add_u32 v4, v4, v148
    v_add_u32 v5, 4, v18
    v_xor_b32 v5, v5, v19
    v_lshlrev_b32 v5, 4, v5
    v_add_u32 v148, 24, v17
    v_lshlrev_b32 v148, 10, v148
    v_add_u32 v5, v5, v148
    v_and_b32 v17, 31, v1
    v_lshrrev_b32 v18, 5, v1
    v_lshrrev_b32 v19, 1, v17
    v_and_b32 v19, 7, v19
    v_xor_b32 v19, v19, v18
    v_lshlrev_b32 v17, 7, v17
    s_lshl_b32 s35, s28, 12
    v_add_u32 v17, s35, v17
    v_xor_b32 v8, 0, v19
    v_lshlrev_b32 v8, 4, v8
    v_add_u32 v8, v8, v17
    v_xor_b32 v9, 2, v19
    v_lshlrev_b32 v9, 4, v9
    v_add_u32 v9, v9, v17
    v_xor_b32 v10, 4, v19
    v_lshlrev_b32 v10, 4, v10
    v_add_u32 v10, v10, v17
    v_xor_b32 v11, 6, v19
    v_lshlrev_b32 v11, 4, v11
    v_add_u32 v11, v11, v17
    v_lshrrev_b32 v17, 2, v1
    v_lshlrev_b32 v17, 10, v17
    v_and_b32 v18, 3, v1
    v_lshlrev_b32 v18, 4, v18
    v_add_u32 v6, v17, v18
    v_lshrrev_b32 v17, 5, v1
    v_lshlrev_b32 v17, 3, v17
    v_bfe_u32 v18, v1, 2, 2
    v_add_u32 v17, v17, v18
    v_bfe_u32 v19, v1, 4, 1
    v_and_b32 v148, 3, v1
    v_lshlrev_b32 v148, 3, v148
    v_lshl_add_u32 v148, v19, 5, v148
    v_lshl_add_u32 v12, v17, 6, v148
    s_lshl_b32 s32, s31, 15
    s_lshl_b32 s58, s28, 12
    v_and_b32 v149, 3, v1
    v_lshlrev_b32 v149, 3, v149
    v_lshl_add_u32 v149, v17, 5, v149
    v_mul_u32_u24 v150, 16512, v19
    v_add_u32 v149, v149, v150
    v_add_u32 v13, 98304, v149
    v_lshrrev_b32 v149, 5, v1
    v_lshlrev_b32 v149, 4, v149
    v_add_u32 v14, 132096, v149
    v_add_u32 v15, 81920, v12
    v_add_u32 v12, 65536, v12
    s_lshl_b32 s33, s28, 14
    s_add_u32 s66, s33, 960
    s_add_u32 s33, s33, 896
    s_lshl_b32 s59, s28, 10
    s_add_u32 s67, s59, 81920
    s_add_u32 s59, s59, 65536
    v_lshlrev_b32 v7, 4, v1
    s_lshl_b32 s34, s28, 12
    s_add_u32 s60, s34, 98304
    s_add_u32 s62, s34, 114816
    s_waitcnt lgkmcnt(0)
    s_mov_b32 s4, s36
    s_mov_b32 s5, s37
    s_mov_b32 s6, 0x200000
    s_mov_b32 s7, 0x00020000
    s_mov_b32 s8, s38
    s_mov_b32 s9, s39
    s_mov_b32 s10, 0x80000
    s_mov_b32 s11, 0x00020000
    s_mov_b32 s16, s56
    s_mov_b32 s17, s57
    s_mov_b32 s18, 0x1000000
    s_mov_b32 s19, 0x00020000
    s_mov_b32 s12, s40
    s_mov_b32 s13, s41
    s_mov_b32 s14, 0x4000
    s_mov_b32 s15, 0x00020000
    s_mov_b32 s20, s42
    s_mov_b32 s21, s43
    s_mov_b32 s22, 0x4000
    s_mov_b32 s23, 0x00020000
    s_mov_b32 s24, s54
    s_mov_b32 s25, s55
    s_mov_b32 s26, 0x400
    s_mov_b32 s27, 0x00020000
    s_mov_b32 m0, s60
    s_nop 0
    buffer_load_dwordx4 v7, s[12:15], s34 offen lds
    s_add_u32 m0, s60, 1024
    s_add_u32 s61, s34, 1024
    buffer_load_dwordx4 v7, s[12:15], s61 offen lds
    s_add_u32 m0, s60, 2048
    s_add_u32 s61, s34, 2048
    buffer_load_dwordx4 v7, s[12:15], s61 offen lds
    s_add_u32 m0, s60, 3072
    s_add_u32 s61, s34, 3072
    buffer_load_dwordx4 v7, s[12:15], s61 offen lds
    s_mov_b32 m0, s62
    s_nop 0
    buffer_load_dwordx4 v7, s[20:23], s34 offen lds
    s_add_u32 m0, s62, 1024
    s_add_u32 s61, s34, 1024
    buffer_load_dwordx4 v7, s[20:23], s61 offen lds
    s_add_u32 m0, s62, 2048
    s_add_u32 s61, s34, 2048
    buffer_load_dwordx4 v7, s[20:23], s61 offen lds
    s_add_u32 m0, s62, 3072
    s_add_u32 s61, s34, 3072
    buffer_load_dwordx4 v7, s[20:23], s61 offen lds
    s_mov_b32 s62, 132096
    s_mov_b32 s63, 0
    s_mov_b32 m0, s62
    s_nop 0
    buffer_load_dwordx4 v7, s[24:27], s63 offen lds
    s_mov_b32 m0, s58
    s_nop 0
    buffer_load_dwordx4 v2, s[4:7], s32 offen lds
    s_add_u32 m0, s58, 1024
    s_nop 0
    buffer_load_dwordx4 v3, s[4:7], s32 offen lds
    s_add_u32 m0, s58, 2048
    s_nop 0
    buffer_load_dwordx4 v4, s[4:7], s32 offen lds
    s_add_u32 m0, s58, 3072
    s_nop 0
    buffer_load_dwordx4 v5, s[4:7], s32 offen lds
    s_mov_b32 m0, s59
    s_nop 0
    buffer_load_dwordx4 v6, s[8:11], s33 offen lds
    s_mov_b32 m0, s67
    s_nop 0
    buffer_load_dwordx4 v6, s[8:11], s66 offen lds
    s_add_u32 m0, s58, 16384
    s_add_u32 s61, s32, 128
    buffer_load_dwordx4 v2, s[4:7], s61 offen lds
    s_add_u32 m0, s58, 17408
    s_add_u32 s61, s32, 128
    buffer_load_dwordx4 v3, s[4:7], s61 offen lds
    s_add_u32 m0, s58, 18432
    s_add_u32 s61, s32, 128
    buffer_load_dwordx4 v4, s[4:7], s61 offen lds
    s_add_u32 m0, s58, 19456
    s_add_u32 s61, s32, 128
    buffer_load_dwordx4 v5, s[4:7], s61 offen lds
    s_add_u32 m0, s59, 4096
    s_add_u32 s61, s33, 65536
    buffer_load_dwordx4 v6, s[8:11], s61 offen lds
    s_add_u32 m0, s67, 4096
    s_add_u32 s61, s66, 65536
    buffer_load_dwordx4 v6, s[8:11], s61 offen lds
    s_add_u32 m0, s58, 32768
    s_add_u32 s61, s32, 256
    buffer_load_dwordx4 v2, s[4:7], s61 offen lds
    s_add_u32 m0, s58, 33792
    s_add_u32 s61, s32, 256
    buffer_load_dwordx4 v3, s[4:7], s61 offen lds
    s_add_u32 m0, s58, 34816
    s_add_u32 s61, s32, 256
    buffer_load_dwordx4 v4, s[4:7], s61 offen lds
    s_add_u32 m0, s58, 35840
    s_add_u32 s61, s32, 256
    buffer_load_dwordx4 v5, s[4:7], s61 offen lds
    s_add_u32 m0, s59, 8192
    s_add_u32 s61, s33, 131072
    buffer_load_dwordx4 v6, s[8:11], s61 offen lds
    s_add_u32 m0, s67, 8192
    s_add_u32 s61, s66, 131072
    buffer_load_dwordx4 v6, s[8:11], s61 offen lds
    s_add_u32 m0, s58, 49152
    s_add_u32 s61, s32, 384
    buffer_load_dwordx4 v2, s[4:7], s61 offen lds
    s_add_u32 m0, s58, 50176
    s_add_u32 s61, s32, 384
    buffer_load_dwordx4 v3, s[4:7], s61 offen lds
    s_add_u32 m0, s58, 51200
    s_add_u32 s61, s32, 384
    buffer_load_dwordx4 v4, s[4:7], s61 offen lds
    s_add_u32 m0, s58, 52224
    s_add_u32 s61, s32, 384
    buffer_load_dwordx4 v5, s[4:7], s61 offen lds
    s_add_u32 m0, s59, 12288
    s_add_u32 s61, s33, 196608
    buffer_load_dwordx4 v6, s[8:11], s61 offen lds
    s_add_u32 m0, s67, 12288
    s_add_u32 s61, s66, 196608
    buffer_load_dwordx4 v6, s[8:11], s61 offen lds
    s_waitcnt vmcnt(18)
    s_barrier
    ds_read_b128 v[100:103], v8 offset:0
    ds_read_b64_tr_b16 v[108:109], v12 offset:0
    ds_read_b64_tr_b16 v[110:111], v12 offset:256
    ds_read_b64_tr_b16 v[112:113], v15 offset:0
    ds_read_b64_tr_b16 v[114:115], v15 offset:256
    ds_read_b64_tr_b16 v[116:117], v13 offset:0
    ds_read_b64_tr_b16 v[118:119], v13 offset:128
    ds_read_b128 v[124:127], v14 offset:0
    s_waitcnt lgkmcnt(5)
    v_mfma_f32_32x32x16_bf16 v[20:35], v[108:111], v[100:103], 0
    ds_read_b128 v[104:107], v9 offset:0
    ds_read_b64_tr_b16 v[128:129], v12 offset:1024
    ds_read_b64_tr_b16 v[130:131], v12 offset:1280
    s_waitcnt lgkmcnt(6)
    v_mfma_f32_32x32x16_bf16 v[36:51], v[112:115], v[100:103], 0
    ds_read_b64_tr_b16 v[132:133], v15 offset:1024
    ds_read_b64_tr_b16 v[134:135], v15 offset:1280
    s_waitcnt lgkmcnt(6)
    v_mfma_f32_32x32x16_bf16 v[52:67], v[116:119], v[100:103], 0
    ds_read_b64_tr_b16 v[136:137], v13 offset:512
    ds_read_b64_tr_b16 v[138:139], v13 offset:640
    s_waitcnt lgkmcnt(8)
    v_mfma_f32_32x32x16_bf16 v[68:83], v[100:103], v[116:119], 0
    s_waitcnt lgkmcnt(7)
    v_mfma_f32_32x32x16_bf16 v[84:99], v[124:127], v[100:103], 0
    ds_read_b128 v[144:147], v14 offset:32
    s_waitcnt lgkmcnt(5)
    v_mfma_f32_32x32x16_bf16 v[20:35], v[128:131], v[104:107], v[20:35]
    ds_read_b128 v[100:103], v10 offset:0
    ds_read_b64_tr_b16 v[108:109], v12 offset:2048
    ds_read_b64_tr_b16 v[110:111], v12 offset:2304
    s_waitcnt lgkmcnt(6)
    v_mfma_f32_32x32x16_bf16 v[36:51], v[132:135], v[104:107], v[36:51]
    ds_read_b64_tr_b16 v[112:113], v15 offset:2048
    ds_read_b64_tr_b16 v[114:115], v15 offset:2304
    s_waitcnt lgkmcnt(6)
    v_mfma_f32_32x32x16_bf16 v[52:67], v[136:139], v[104:107], v[52:67]
    ds_read_b64_tr_b16 v[116:117], v13 offset:1024
    ds_read_b64_tr_b16 v[118:119], v13 offset:1152
    s_waitcnt lgkmcnt(8)
    v_mfma_f32_32x32x16_bf16 v[68:83], v[104:107], v[136:139], v[68:83]
    s_waitcnt lgkmcnt(7)
    v_mfma_f32_32x32x16_bf16 v[84:99], v[144:147], v[104:107], v[84:99]
    ds_read_b128 v[124:127], v14 offset:64
    s_waitcnt lgkmcnt(5)
    v_mfma_f32_32x32x16_bf16 v[20:35], v[108:111], v[100:103], v[20:35]
    ds_read_b128 v[104:107], v11 offset:0
    ds_read_b64_tr_b16 v[128:129], v12 offset:3072
    ds_read_b64_tr_b16 v[130:131], v12 offset:3328
    s_waitcnt lgkmcnt(6)
    v_mfma_f32_32x32x16_bf16 v[36:51], v[112:115], v[100:103], v[36:51]
    ds_read_b64_tr_b16 v[132:133], v15 offset:3072
    ds_read_b64_tr_b16 v[134:135], v15 offset:3328
    s_waitcnt lgkmcnt(6)
    v_mfma_f32_32x32x16_bf16 v[52:67], v[116:119], v[100:103], v[52:67]
    ds_read_b64_tr_b16 v[136:137], v13 offset:1536
    ds_read_b64_tr_b16 v[138:139], v13 offset:1664
    s_waitcnt lgkmcnt(8)
    v_mfma_f32_32x32x16_bf16 v[68:83], v[100:103], v[116:119], v[68:83]
    s_waitcnt lgkmcnt(7)
    v_mfma_f32_32x32x16_bf16 v[84:99], v[124:127], v[100:103], v[84:99]
    ds_read_b128 v[144:147], v14 offset:96
    s_waitcnt lgkmcnt(5)
    v_mfma_f32_32x32x16_bf16 v[20:35], v[128:131], v[104:107], v[20:35]
    s_waitcnt vmcnt(12)
    s_barrier
    ds_read_b128 v[100:103], v8 offset:16384
    ds_read_b64_tr_b16 v[108:109], v12 offset:4096
    ds_read_b64_tr_b16 v[110:111], v12 offset:4352
    s_waitcnt lgkmcnt(6)
    v_mfma_f32_32x32x16_bf16 v[36:51], v[132:135], v[104:107], v[36:51]
    ds_read_b64_tr_b16 v[112:113], v15 offset:4096
    ds_read_b64_tr_b16 v[114:115], v15 offset:4352
    s_waitcnt lgkmcnt(6)
    v_mfma_f32_32x32x16_bf16 v[52:67], v[136:139], v[104:107], v[52:67]
    ds_read_b64_tr_b16 v[116:117], v13 offset:2048
    ds_read_b64_tr_b16 v[118:119], v13 offset:2176
    s_waitcnt lgkmcnt(8)
    v_mfma_f32_32x32x16_bf16 v[68:83], v[104:107], v[136:139], v[68:83]
    s_waitcnt lgkmcnt(7)
    v_mfma_f32_32x32x16_bf16 v[84:99], v[144:147], v[104:107], v[84:99]
    ds_read_b128 v[124:127], v14 offset:128
    s_waitcnt lgkmcnt(5)
    v_mfma_f32_32x32x16_bf16 v[20:35], v[108:111], v[100:103], v[20:35]
    ds_read_b128 v[104:107], v9 offset:16384
    ds_read_b64_tr_b16 v[128:129], v12 offset:5120
    ds_read_b64_tr_b16 v[130:131], v12 offset:5376
    s_waitcnt lgkmcnt(6)
    v_mfma_f32_32x32x16_bf16 v[36:51], v[112:115], v[100:103], v[36:51]
    ds_read_b64_tr_b16 v[132:133], v15 offset:5120
    ds_read_b64_tr_b16 v[134:135], v15 offset:5376
    s_waitcnt lgkmcnt(6)
    v_mfma_f32_32x32x16_bf16 v[52:67], v[116:119], v[100:103], v[52:67]
    ds_read_b64_tr_b16 v[136:137], v13 offset:2560
    ds_read_b64_tr_b16 v[138:139], v13 offset:2688
    s_waitcnt lgkmcnt(8)
    v_mfma_f32_32x32x16_bf16 v[68:83], v[100:103], v[116:119], v[68:83]
    s_waitcnt lgkmcnt(7)
    v_mfma_f32_32x32x16_bf16 v[84:99], v[124:127], v[100:103], v[84:99]
    ds_read_b128 v[144:147], v14 offset:160
    s_waitcnt lgkmcnt(5)
    v_mfma_f32_32x32x16_bf16 v[20:35], v[128:131], v[104:107], v[20:35]
    ds_read_b128 v[100:103], v10 offset:16384
    ds_read_b64_tr_b16 v[108:109], v12 offset:6144
    ds_read_b64_tr_b16 v[110:111], v12 offset:6400
    s_waitcnt lgkmcnt(6)
    v_mfma_f32_32x32x16_bf16 v[36:51], v[132:135], v[104:107], v[36:51]
    ds_read_b64_tr_b16 v[112:113], v15 offset:6144
    ds_read_b64_tr_b16 v[114:115], v15 offset:6400
    s_waitcnt lgkmcnt(6)
    v_mfma_f32_32x32x16_bf16 v[52:67], v[136:139], v[104:107], v[52:67]
    ds_read_b64_tr_b16 v[116:117], v13 offset:3072
    ds_read_b64_tr_b16 v[118:119], v13 offset:3200
    s_waitcnt lgkmcnt(8)
    v_mfma_f32_32x32x16_bf16 v[68:83], v[104:107], v[136:139], v[68:83]
    s_waitcnt lgkmcnt(7)
    v_mfma_f32_32x32x16_bf16 v[84:99], v[144:147], v[104:107], v[84:99]
    ds_read_b128 v[124:127], v14 offset:192
    s_waitcnt lgkmcnt(5)
    v_mfma_f32_32x32x16_bf16 v[20:35], v[108:111], v[100:103], v[20:35]
    ds_read_b128 v[104:107], v11 offset:16384
    ds_read_b64_tr_b16 v[128:129], v12 offset:7168
    ds_read_b64_tr_b16 v[130:131], v12 offset:7424
    s_waitcnt lgkmcnt(6)
    v_mfma_f32_32x32x16_bf16 v[36:51], v[112:115], v[100:103], v[36:51]
    ds_read_b64_tr_b16 v[132:133], v15 offset:7168
    ds_read_b64_tr_b16 v[134:135], v15 offset:7424
    s_waitcnt lgkmcnt(6)
    v_mfma_f32_32x32x16_bf16 v[52:67], v[116:119], v[100:103], v[52:67]
    ds_read_b64_tr_b16 v[136:137], v13 offset:3584
    ds_read_b64_tr_b16 v[138:139], v13 offset:3712
    s_waitcnt lgkmcnt(8)
    v_mfma_f32_32x32x16_bf16 v[68:83], v[100:103], v[116:119], v[68:83]
    s_waitcnt lgkmcnt(7)
    v_mfma_f32_32x32x16_bf16 v[84:99], v[124:127], v[100:103], v[84:99]
    ds_read_b128 v[144:147], v14 offset:224
    s_waitcnt lgkmcnt(5)
    v_mfma_f32_32x32x16_bf16 v[20:35], v[128:131], v[104:107], v[20:35]
    s_waitcnt vmcnt(6)
    s_barrier
    ds_read_b128 v[100:103], v8 offset:32768
    ds_read_b64_tr_b16 v[108:109], v12 offset:8192
    ds_read_b64_tr_b16 v[110:111], v12 offset:8448
    s_waitcnt lgkmcnt(6)
    v_mfma_f32_32x32x16_bf16 v[36:51], v[132:135], v[104:107], v[36:51]
    ds_read_b64_tr_b16 v[112:113], v15 offset:8192
    ds_read_b64_tr_b16 v[114:115], v15 offset:8448
    s_mov_b32 m0, s58
    s_add_u32 s61, s32, 512
    buffer_load_dwordx4 v2, s[4:7], s61 offen lds
    s_waitcnt lgkmcnt(6)
    v_mfma_f32_32x32x16_bf16 v[52:67], v[136:139], v[104:107], v[52:67]
    ds_read_b64_tr_b16 v[116:117], v13 offset:4096
    ds_read_b64_tr_b16 v[118:119], v13 offset:4224
    s_add_u32 m0, s58, 1024
    s_add_u32 s61, s32, 512
    buffer_load_dwordx4 v3, s[4:7], s61 offen lds
    s_waitcnt lgkmcnt(8)
    v_mfma_f32_32x32x16_bf16 v[68:83], v[104:107], v[136:139], v[68:83]
    s_add_u32 m0, s58, 2048
    s_add_u32 s61, s32, 512
    buffer_load_dwordx4 v4, s[4:7], s61 offen lds
    s_waitcnt lgkmcnt(7)
    v_mfma_f32_32x32x16_bf16 v[84:99], v[144:147], v[104:107], v[84:99]
    ds_read_b128 v[124:127], v14 offset:256
    s_add_u32 m0, s58, 3072
    s_add_u32 s61, s32, 512
    buffer_load_dwordx4 v5, s[4:7], s61 offen lds
    s_waitcnt lgkmcnt(5)
    v_mfma_f32_32x32x16_bf16 v[20:35], v[108:111], v[100:103], v[20:35]
    ds_read_b128 v[104:107], v9 offset:32768
    ds_read_b64_tr_b16 v[128:129], v12 offset:9216
    ds_read_b64_tr_b16 v[130:131], v12 offset:9472
    s_mov_b32 m0, s59
    s_add_u32 s61, s33, 262144
    buffer_load_dwordx4 v6, s[8:11], s61 offen lds
    s_waitcnt lgkmcnt(6)
    v_mfma_f32_32x32x16_bf16 v[36:51], v[112:115], v[100:103], v[36:51]
    ds_read_b64_tr_b16 v[132:133], v15 offset:9216
    ds_read_b64_tr_b16 v[134:135], v15 offset:9472
    s_mov_b32 m0, s67
    s_add_u32 s61, s66, 262144
    buffer_load_dwordx4 v6, s[8:11], s61 offen lds
    s_waitcnt lgkmcnt(6)
    v_mfma_f32_32x32x16_bf16 v[52:67], v[116:119], v[100:103], v[52:67]
    ds_read_b64_tr_b16 v[136:137], v13 offset:4608
    ds_read_b64_tr_b16 v[138:139], v13 offset:4736
    s_waitcnt lgkmcnt(8)
    v_mfma_f32_32x32x16_bf16 v[68:83], v[100:103], v[116:119], v[68:83]
    s_waitcnt lgkmcnt(7)
    v_mfma_f32_32x32x16_bf16 v[84:99], v[124:127], v[100:103], v[84:99]
    ds_read_b128 v[144:147], v14 offset:288
    s_waitcnt lgkmcnt(5)
    v_mfma_f32_32x32x16_bf16 v[20:35], v[128:131], v[104:107], v[20:35]
    ds_read_b128 v[100:103], v10 offset:32768
    ds_read_b64_tr_b16 v[108:109], v12 offset:10240
    ds_read_b64_tr_b16 v[110:111], v12 offset:10496
    s_waitcnt lgkmcnt(6)
    v_mfma_f32_32x32x16_bf16 v[36:51], v[132:135], v[104:107], v[36:51]
    ds_read_b64_tr_b16 v[112:113], v15 offset:10240
    ds_read_b64_tr_b16 v[114:115], v15 offset:10496
    s_waitcnt lgkmcnt(6)
    v_mfma_f32_32x32x16_bf16 v[52:67], v[136:139], v[104:107], v[52:67]
    ds_read_b64_tr_b16 v[116:117], v13 offset:5120
    ds_read_b64_tr_b16 v[118:119], v13 offset:5248
    s_waitcnt lgkmcnt(8)
    v_mfma_f32_32x32x16_bf16 v[68:83], v[104:107], v[136:139], v[68:83]
    s_waitcnt lgkmcnt(7)
    v_mfma_f32_32x32x16_bf16 v[84:99], v[144:147], v[104:107], v[84:99]
    ds_read_b128 v[124:127], v14 offset:320
    s_waitcnt lgkmcnt(5)
    v_mfma_f32_32x32x16_bf16 v[20:35], v[108:111], v[100:103], v[20:35]
    ds_read_b128 v[104:107], v11 offset:32768
    ds_read_b64_tr_b16 v[128:129], v12 offset:11264
    ds_read_b64_tr_b16 v[130:131], v12 offset:11520
    s_waitcnt lgkmcnt(6)
    v_mfma_f32_32x32x16_bf16 v[36:51], v[112:115], v[100:103], v[36:51]
    ds_read_b64_tr_b16 v[132:133], v15 offset:11264
    ds_read_b64_tr_b16 v[134:135], v15 offset:11520
    s_waitcnt lgkmcnt(6)
    v_mfma_f32_32x32x16_bf16 v[52:67], v[116:119], v[100:103], v[52:67]
    ds_read_b64_tr_b16 v[136:137], v13 offset:5632
    ds_read_b64_tr_b16 v[138:139], v13 offset:5760
    s_waitcnt lgkmcnt(8)
    v_mfma_f32_32x32x16_bf16 v[68:83], v[100:103], v[116:119], v[68:83]
    s_waitcnt lgkmcnt(7)
    v_mfma_f32_32x32x16_bf16 v[84:99], v[124:127], v[100:103], v[84:99]
    ds_read_b128 v[144:147], v14 offset:352
    s_waitcnt lgkmcnt(5)
    v_mfma_f32_32x32x16_bf16 v[20:35], v[128:131], v[104:107], v[20:35]
    s_waitcnt vmcnt(6)
    s_barrier
    ds_read_b128 v[100:103], v8 offset:49152
    ds_read_b64_tr_b16 v[108:109], v12 offset:12288
    ds_read_b64_tr_b16 v[110:111], v12 offset:12544
    s_waitcnt lgkmcnt(6)
    v_mfma_f32_32x32x16_bf16 v[36:51], v[132:135], v[104:107], v[36:51]
    ds_read_b64_tr_b16 v[112:113], v15 offset:12288
    ds_read_b64_tr_b16 v[114:115], v15 offset:12544
    s_add_u32 m0, s58, 16384
    s_add_u32 s61, s32, 640
    buffer_load_dwordx4 v2, s[4:7], s61 offen lds
    s_waitcnt lgkmcnt(6)
    v_mfma_f32_32x32x16_bf16 v[52:67], v[136:139], v[104:107], v[52:67]
    ds_read_b64_tr_b16 v[116:117], v13 offset:6144
    ds_read_b64_tr_b16 v[118:119], v13 offset:6272
    s_add_u32 m0, s58, 17408
    s_add_u32 s61, s32, 640
    buffer_load_dwordx4 v3, s[4:7], s61 offen lds
    s_waitcnt lgkmcnt(8)
    v_mfma_f32_32x32x16_bf16 v[68:83], v[104:107], v[136:139], v[68:83]
    s_add_u32 m0, s58, 18432
    s_add_u32 s61, s32, 640
    buffer_load_dwordx4 v4, s[4:7], s61 offen lds
    s_waitcnt lgkmcnt(7)
    v_mfma_f32_32x32x16_bf16 v[84:99], v[144:147], v[104:107], v[84:99]
    ds_read_b128 v[124:127], v14 offset:384
    s_add_u32 m0, s58, 19456
    s_add_u32 s61, s32, 640
    buffer_load_dwordx4 v5, s[4:7], s61 offen lds
    s_waitcnt lgkmcnt(5)
    v_mfma_f32_32x32x16_bf16 v[20:35], v[108:111], v[100:103], v[20:35]
    ds_read_b128 v[104:107], v9 offset:49152
    ds_read_b64_tr_b16 v[128:129], v12 offset:13312
    ds_read_b64_tr_b16 v[130:131], v12 offset:13568
    s_add_u32 m0, s59, 4096
    s_add_u32 s61, s33, 327680
    buffer_load_dwordx4 v6, s[8:11], s61 offen lds
    s_waitcnt lgkmcnt(6)
    v_mfma_f32_32x32x16_bf16 v[36:51], v[112:115], v[100:103], v[36:51]
    ds_read_b64_tr_b16 v[132:133], v15 offset:13312
    ds_read_b64_tr_b16 v[134:135], v15 offset:13568
    s_add_u32 m0, s67, 4096
    s_add_u32 s61, s66, 327680
    buffer_load_dwordx4 v6, s[8:11], s61 offen lds
    s_waitcnt lgkmcnt(6)
    v_mfma_f32_32x32x16_bf16 v[52:67], v[116:119], v[100:103], v[52:67]
    ds_read_b64_tr_b16 v[136:137], v13 offset:6656
    ds_read_b64_tr_b16 v[138:139], v13 offset:6784
    s_waitcnt lgkmcnt(8)
    v_mfma_f32_32x32x16_bf16 v[68:83], v[100:103], v[116:119], v[68:83]
    s_waitcnt lgkmcnt(7)
    v_mfma_f32_32x32x16_bf16 v[84:99], v[124:127], v[100:103], v[84:99]
    ds_read_b128 v[144:147], v14 offset:416
    s_waitcnt lgkmcnt(5)
    v_mfma_f32_32x32x16_bf16 v[20:35], v[128:131], v[104:107], v[20:35]
    ds_read_b128 v[100:103], v10 offset:49152
    ds_read_b64_tr_b16 v[108:109], v12 offset:14336
    ds_read_b64_tr_b16 v[110:111], v12 offset:14592
    s_waitcnt lgkmcnt(6)
    v_mfma_f32_32x32x16_bf16 v[36:51], v[132:135], v[104:107], v[36:51]
    ds_read_b64_tr_b16 v[112:113], v15 offset:14336
    ds_read_b64_tr_b16 v[114:115], v15 offset:14592
    s_waitcnt lgkmcnt(6)
    v_mfma_f32_32x32x16_bf16 v[52:67], v[136:139], v[104:107], v[52:67]
    ds_read_b64_tr_b16 v[116:117], v13 offset:7168
    ds_read_b64_tr_b16 v[118:119], v13 offset:7296
    s_waitcnt lgkmcnt(8)
    v_mfma_f32_32x32x16_bf16 v[68:83], v[104:107], v[136:139], v[68:83]
    s_waitcnt lgkmcnt(7)
    v_mfma_f32_32x32x16_bf16 v[84:99], v[144:147], v[104:107], v[84:99]
    ds_read_b128 v[124:127], v14 offset:448
    s_waitcnt lgkmcnt(5)
    v_mfma_f32_32x32x16_bf16 v[20:35], v[108:111], v[100:103], v[20:35]
    ds_read_b128 v[104:107], v11 offset:49152
    ds_read_b64_tr_b16 v[128:129], v12 offset:15360
    ds_read_b64_tr_b16 v[130:131], v12 offset:15616
    s_waitcnt lgkmcnt(6)
    v_mfma_f32_32x32x16_bf16 v[36:51], v[112:115], v[100:103], v[36:51]
    ds_read_b64_tr_b16 v[132:133], v15 offset:15360
    ds_read_b64_tr_b16 v[134:135], v15 offset:15616
    s_waitcnt lgkmcnt(6)
    v_mfma_f32_32x32x16_bf16 v[52:67], v[116:119], v[100:103], v[52:67]
    ds_read_b64_tr_b16 v[136:137], v13 offset:7680
    ds_read_b64_tr_b16 v[138:139], v13 offset:7808
    s_waitcnt lgkmcnt(8)
    v_mfma_f32_32x32x16_bf16 v[68:83], v[100:103], v[116:119], v[68:83]
    s_waitcnt lgkmcnt(7)
    v_mfma_f32_32x32x16_bf16 v[84:99], v[124:127], v[100:103], v[84:99]
    ds_read_b128 v[144:147], v14 offset:480
    s_waitcnt lgkmcnt(5)
    v_mfma_f32_32x32x16_bf16 v[20:35], v[128:131], v[104:107], v[20:35]
    s_waitcnt vmcnt(6)
    s_barrier
    ds_read_b128 v[100:103], v8 offset:0
    ds_read_b64_tr_b16 v[108:109], v12 offset:0
    ds_read_b64_tr_b16 v[110:111], v12 offset:256
    s_waitcnt lgkmcnt(6)
    v_mfma_f32_32x32x16_bf16 v[36:51], v[132:135], v[104:107], v[36:51]
    ds_read_b64_tr_b16 v[112:113], v15 offset:0
    ds_read_b64_tr_b16 v[114:115], v15 offset:256
    s_add_u32 m0, s58, 32768
    s_add_u32 s61, s32, 768
    buffer_load_dwordx4 v2, s[4:7], s61 offen lds
    s_waitcnt lgkmcnt(6)
    v_mfma_f32_32x32x16_bf16 v[52:67], v[136:139], v[104:107], v[52:67]
    ds_read_b64_tr_b16 v[116:117], v13 offset:8192
    ds_read_b64_tr_b16 v[118:119], v13 offset:8320
    s_add_u32 m0, s58, 33792
    s_add_u32 s61, s32, 768
    buffer_load_dwordx4 v3, s[4:7], s61 offen lds
    s_waitcnt lgkmcnt(8)
    v_mfma_f32_32x32x16_bf16 v[68:83], v[104:107], v[136:139], v[68:83]
    s_add_u32 m0, s58, 34816
    s_add_u32 s61, s32, 768
    buffer_load_dwordx4 v4, s[4:7], s61 offen lds
    s_waitcnt lgkmcnt(7)
    v_mfma_f32_32x32x16_bf16 v[84:99], v[144:147], v[104:107], v[84:99]
    ds_read_b128 v[124:127], v14 offset:512
    s_add_u32 m0, s58, 35840
    s_add_u32 s61, s32, 768
    buffer_load_dwordx4 v5, s[4:7], s61 offen lds
    s_waitcnt lgkmcnt(5)
    v_mfma_f32_32x32x16_bf16 v[20:35], v[108:111], v[100:103], v[20:35]
    ds_read_b128 v[104:107], v9 offset:0
    ds_read_b64_tr_b16 v[128:129], v12 offset:1024
    ds_read_b64_tr_b16 v[130:131], v12 offset:1280
    s_add_u32 m0, s59, 8192
    s_add_u32 s61, s33, 393216
    buffer_load_dwordx4 v6, s[8:11], s61 offen lds
    s_waitcnt lgkmcnt(6)
    v_mfma_f32_32x32x16_bf16 v[36:51], v[112:115], v[100:103], v[36:51]
    ds_read_b64_tr_b16 v[132:133], v15 offset:1024
    ds_read_b64_tr_b16 v[134:135], v15 offset:1280
    s_add_u32 m0, s67, 8192
    s_add_u32 s61, s66, 393216
    buffer_load_dwordx4 v6, s[8:11], s61 offen lds
    s_waitcnt lgkmcnt(6)
    v_mfma_f32_32x32x16_bf16 v[52:67], v[116:119], v[100:103], v[52:67]
    ds_read_b64_tr_b16 v[136:137], v13 offset:8704
    ds_read_b64_tr_b16 v[138:139], v13 offset:8832
    s_waitcnt lgkmcnt(8)
    v_mfma_f32_32x32x16_bf16 v[68:83], v[100:103], v[116:119], v[68:83]
    s_waitcnt lgkmcnt(7)
    v_mfma_f32_32x32x16_bf16 v[84:99], v[124:127], v[100:103], v[84:99]
    ds_read_b128 v[144:147], v14 offset:544
    s_waitcnt lgkmcnt(5)
    v_mfma_f32_32x32x16_bf16 v[20:35], v[128:131], v[104:107], v[20:35]
    ds_read_b128 v[100:103], v10 offset:0
    ds_read_b64_tr_b16 v[108:109], v12 offset:2048
    ds_read_b64_tr_b16 v[110:111], v12 offset:2304
    s_waitcnt lgkmcnt(6)
    v_mfma_f32_32x32x16_bf16 v[36:51], v[132:135], v[104:107], v[36:51]
    ds_read_b64_tr_b16 v[112:113], v15 offset:2048
    ds_read_b64_tr_b16 v[114:115], v15 offset:2304
    s_waitcnt lgkmcnt(6)
    v_mfma_f32_32x32x16_bf16 v[52:67], v[136:139], v[104:107], v[52:67]
    ds_read_b64_tr_b16 v[116:117], v13 offset:9216
    ds_read_b64_tr_b16 v[118:119], v13 offset:9344
    s_waitcnt lgkmcnt(8)
    v_mfma_f32_32x32x16_bf16 v[68:83], v[104:107], v[136:139], v[68:83]
    s_waitcnt lgkmcnt(7)
    v_mfma_f32_32x32x16_bf16 v[84:99], v[144:147], v[104:107], v[84:99]
    ds_read_b128 v[124:127], v14 offset:576
    s_waitcnt lgkmcnt(5)
    v_mfma_f32_32x32x16_bf16 v[20:35], v[108:111], v[100:103], v[20:35]
    ds_read_b128 v[104:107], v11 offset:0
    ds_read_b64_tr_b16 v[128:129], v12 offset:3072
    ds_read_b64_tr_b16 v[130:131], v12 offset:3328
    s_waitcnt lgkmcnt(6)
    v_mfma_f32_32x32x16_bf16 v[36:51], v[112:115], v[100:103], v[36:51]
    ds_read_b64_tr_b16 v[132:133], v15 offset:3072
    ds_read_b64_tr_b16 v[134:135], v15 offset:3328
    s_waitcnt lgkmcnt(6)
    v_mfma_f32_32x32x16_bf16 v[52:67], v[116:119], v[100:103], v[52:67]
    ds_read_b64_tr_b16 v[136:137], v13 offset:9728
    ds_read_b64_tr_b16 v[138:139], v13 offset:9856
    s_waitcnt lgkmcnt(8)
    v_mfma_f32_32x32x16_bf16 v[68:83], v[100:103], v[116:119], v[68:83]
    s_waitcnt lgkmcnt(7)
    v_mfma_f32_32x32x16_bf16 v[84:99], v[124:127], v[100:103], v[84:99]
    ds_read_b128 v[144:147], v14 offset:608
    s_waitcnt lgkmcnt(5)
    v_mfma_f32_32x32x16_bf16 v[20:35], v[128:131], v[104:107], v[20:35]
    s_waitcnt vmcnt(6)
    s_barrier
    ds_read_b128 v[100:103], v8 offset:16384
    ds_read_b64_tr_b16 v[108:109], v12 offset:4096
    ds_read_b64_tr_b16 v[110:111], v12 offset:4352
    s_waitcnt lgkmcnt(6)
    v_mfma_f32_32x32x16_bf16 v[36:51], v[132:135], v[104:107], v[36:51]
    ds_read_b64_tr_b16 v[112:113], v15 offset:4096
    ds_read_b64_tr_b16 v[114:115], v15 offset:4352
    s_add_u32 m0, s58, 49152
    s_add_u32 s61, s32, 896
    buffer_load_dwordx4 v2, s[4:7], s61 offen lds
    s_waitcnt lgkmcnt(6)
    v_mfma_f32_32x32x16_bf16 v[52:67], v[136:139], v[104:107], v[52:67]
    ds_read_b64_tr_b16 v[116:117], v13 offset:10240
    ds_read_b64_tr_b16 v[118:119], v13 offset:10368
    s_add_u32 m0, s58, 50176
    s_add_u32 s61, s32, 896
    buffer_load_dwordx4 v3, s[4:7], s61 offen lds
    s_waitcnt lgkmcnt(8)
    v_mfma_f32_32x32x16_bf16 v[68:83], v[104:107], v[136:139], v[68:83]
    s_add_u32 m0, s58, 51200
    s_add_u32 s61, s32, 896
    buffer_load_dwordx4 v4, s[4:7], s61 offen lds
    s_waitcnt lgkmcnt(7)
    v_mfma_f32_32x32x16_bf16 v[84:99], v[144:147], v[104:107], v[84:99]
    ds_read_b128 v[124:127], v14 offset:640
    s_add_u32 m0, s58, 52224
    s_add_u32 s61, s32, 896
    buffer_load_dwordx4 v5, s[4:7], s61 offen lds
    s_waitcnt lgkmcnt(5)
    v_mfma_f32_32x32x16_bf16 v[20:35], v[108:111], v[100:103], v[20:35]
    ds_read_b128 v[104:107], v9 offset:16384
    ds_read_b64_tr_b16 v[128:129], v12 offset:5120
    ds_read_b64_tr_b16 v[130:131], v12 offset:5376
    s_add_u32 m0, s59, 12288
    s_add_u32 s61, s33, 458752
    buffer_load_dwordx4 v6, s[8:11], s61 offen lds
    s_waitcnt lgkmcnt(6)
    v_mfma_f32_32x32x16_bf16 v[36:51], v[112:115], v[100:103], v[36:51]
    ds_read_b64_tr_b16 v[132:133], v15 offset:5120
    ds_read_b64_tr_b16 v[134:135], v15 offset:5376
    s_add_u32 m0, s67, 12288
    s_add_u32 s61, s66, 458752
    buffer_load_dwordx4 v6, s[8:11], s61 offen lds
    s_waitcnt lgkmcnt(6)
    v_mfma_f32_32x32x16_bf16 v[52:67], v[116:119], v[100:103], v[52:67]
    ds_read_b64_tr_b16 v[136:137], v13 offset:10752
    ds_read_b64_tr_b16 v[138:139], v13 offset:10880
    s_waitcnt lgkmcnt(8)
    v_mfma_f32_32x32x16_bf16 v[68:83], v[100:103], v[116:119], v[68:83]
    s_waitcnt lgkmcnt(7)
    v_mfma_f32_32x32x16_bf16 v[84:99], v[124:127], v[100:103], v[84:99]
    ds_read_b128 v[144:147], v14 offset:672
    s_waitcnt lgkmcnt(5)
    v_mfma_f32_32x32x16_bf16 v[20:35], v[128:131], v[104:107], v[20:35]
    ds_read_b128 v[100:103], v10 offset:16384
    ds_read_b64_tr_b16 v[108:109], v12 offset:6144
    ds_read_b64_tr_b16 v[110:111], v12 offset:6400
    s_waitcnt lgkmcnt(6)
    v_mfma_f32_32x32x16_bf16 v[36:51], v[132:135], v[104:107], v[36:51]
    ds_read_b64_tr_b16 v[112:113], v15 offset:6144
    ds_read_b64_tr_b16 v[114:115], v15 offset:6400
    s_waitcnt lgkmcnt(6)
    v_mfma_f32_32x32x16_bf16 v[52:67], v[136:139], v[104:107], v[52:67]
    ds_read_b64_tr_b16 v[116:117], v13 offset:11264
    ds_read_b64_tr_b16 v[118:119], v13 offset:11392
    s_waitcnt lgkmcnt(8)
    v_mfma_f32_32x32x16_bf16 v[68:83], v[104:107], v[136:139], v[68:83]
    s_waitcnt lgkmcnt(7)
    v_mfma_f32_32x32x16_bf16 v[84:99], v[144:147], v[104:107], v[84:99]
    ds_read_b128 v[124:127], v14 offset:704
    s_waitcnt lgkmcnt(5)
    v_mfma_f32_32x32x16_bf16 v[20:35], v[108:111], v[100:103], v[20:35]
    ds_read_b128 v[104:107], v11 offset:16384
    ds_read_b64_tr_b16 v[128:129], v12 offset:7168
    ds_read_b64_tr_b16 v[130:131], v12 offset:7424
    s_waitcnt lgkmcnt(6)
    v_mfma_f32_32x32x16_bf16 v[36:51], v[112:115], v[100:103], v[36:51]
    ds_read_b64_tr_b16 v[132:133], v15 offset:7168
    ds_read_b64_tr_b16 v[134:135], v15 offset:7424
    s_waitcnt lgkmcnt(6)
    v_mfma_f32_32x32x16_bf16 v[52:67], v[116:119], v[100:103], v[52:67]
    ds_read_b64_tr_b16 v[136:137], v13 offset:11776
    ds_read_b64_tr_b16 v[138:139], v13 offset:11904
    s_waitcnt lgkmcnt(8)
    v_mfma_f32_32x32x16_bf16 v[68:83], v[100:103], v[116:119], v[68:83]
    s_waitcnt lgkmcnt(7)
    v_mfma_f32_32x32x16_bf16 v[84:99], v[124:127], v[100:103], v[84:99]
    ds_read_b128 v[144:147], v14 offset:736
    s_waitcnt lgkmcnt(5)
    v_mfma_f32_32x32x16_bf16 v[20:35], v[128:131], v[104:107], v[20:35]
    s_waitcnt vmcnt(6)
    s_barrier
    ds_read_b128 v[100:103], v8 offset:32768
    ds_read_b64_tr_b16 v[108:109], v12 offset:8192
    ds_read_b64_tr_b16 v[110:111], v12 offset:8448
    s_waitcnt lgkmcnt(6)
    v_mfma_f32_32x32x16_bf16 v[36:51], v[132:135], v[104:107], v[36:51]
    ds_read_b64_tr_b16 v[112:113], v15 offset:8192
    ds_read_b64_tr_b16 v[114:115], v15 offset:8448
    s_waitcnt lgkmcnt(6)
    v_mfma_f32_32x32x16_bf16 v[52:67], v[136:139], v[104:107], v[52:67]
    ds_read_b64_tr_b16 v[116:117], v13 offset:12288
    ds_read_b64_tr_b16 v[118:119], v13 offset:12416
    s_waitcnt lgkmcnt(8)
    v_mfma_f32_32x32x16_bf16 v[68:83], v[104:107], v[136:139], v[68:83]
    s_waitcnt lgkmcnt(7)
    v_mfma_f32_32x32x16_bf16 v[84:99], v[144:147], v[104:107], v[84:99]
    ds_read_b128 v[124:127], v14 offset:768
    s_waitcnt lgkmcnt(5)
    v_mfma_f32_32x32x16_bf16 v[20:35], v[108:111], v[100:103], v[20:35]
    ds_read_b128 v[104:107], v9 offset:32768
    ds_read_b64_tr_b16 v[128:129], v12 offset:9216
    ds_read_b64_tr_b16 v[130:131], v12 offset:9472
    s_waitcnt lgkmcnt(6)
    v_mfma_f32_32x32x16_bf16 v[36:51], v[112:115], v[100:103], v[36:51]
    ds_read_b64_tr_b16 v[132:133], v15 offset:9216
    ds_read_b64_tr_b16 v[134:135], v15 offset:9472
    s_waitcnt lgkmcnt(6)
    v_mfma_f32_32x32x16_bf16 v[52:67], v[116:119], v[100:103], v[52:67]
    ds_read_b64_tr_b16 v[136:137], v13 offset:12800
    ds_read_b64_tr_b16 v[138:139], v13 offset:12928
    s_waitcnt lgkmcnt(8)
    v_mfma_f32_32x32x16_bf16 v[68:83], v[100:103], v[116:119], v[68:83]
    s_waitcnt lgkmcnt(7)
    v_mfma_f32_32x32x16_bf16 v[84:99], v[124:127], v[100:103], v[84:99]
    ds_read_b128 v[144:147], v14 offset:800
    s_waitcnt lgkmcnt(5)
    v_mfma_f32_32x32x16_bf16 v[20:35], v[128:131], v[104:107], v[20:35]
    ds_read_b128 v[100:103], v10 offset:32768
    ds_read_b64_tr_b16 v[108:109], v12 offset:10240
    ds_read_b64_tr_b16 v[110:111], v12 offset:10496
    s_waitcnt lgkmcnt(6)
    v_mfma_f32_32x32x16_bf16 v[36:51], v[132:135], v[104:107], v[36:51]
    ds_read_b64_tr_b16 v[112:113], v15 offset:10240
    ds_read_b64_tr_b16 v[114:115], v15 offset:10496
    s_waitcnt lgkmcnt(6)
    v_mfma_f32_32x32x16_bf16 v[52:67], v[136:139], v[104:107], v[52:67]
    ds_read_b64_tr_b16 v[116:117], v13 offset:13312
    ds_read_b64_tr_b16 v[118:119], v13 offset:13440
    s_waitcnt lgkmcnt(8)
    v_mfma_f32_32x32x16_bf16 v[68:83], v[104:107], v[136:139], v[68:83]
    s_waitcnt lgkmcnt(7)
    v_mfma_f32_32x32x16_bf16 v[84:99], v[144:147], v[104:107], v[84:99]
    ds_read_b128 v[124:127], v14 offset:832
    s_waitcnt lgkmcnt(5)
    v_mfma_f32_32x32x16_bf16 v[20:35], v[108:111], v[100:103], v[20:35]
    ds_read_b128 v[104:107], v11 offset:32768
    ds_read_b64_tr_b16 v[128:129], v12 offset:11264
    ds_read_b64_tr_b16 v[130:131], v12 offset:11520
    s_waitcnt lgkmcnt(6)
    v_mfma_f32_32x32x16_bf16 v[36:51], v[112:115], v[100:103], v[36:51]
    ds_read_b64_tr_b16 v[132:133], v15 offset:11264
    ds_read_b64_tr_b16 v[134:135], v15 offset:11520
    s_waitcnt lgkmcnt(6)
    v_mfma_f32_32x32x16_bf16 v[52:67], v[116:119], v[100:103], v[52:67]
    ds_read_b64_tr_b16 v[136:137], v13 offset:13824
    ds_read_b64_tr_b16 v[138:139], v13 offset:13952
    s_waitcnt lgkmcnt(8)
    v_mfma_f32_32x32x16_bf16 v[68:83], v[100:103], v[116:119], v[68:83]
    s_waitcnt lgkmcnt(7)
    v_mfma_f32_32x32x16_bf16 v[84:99], v[124:127], v[100:103], v[84:99]
    ds_read_b128 v[144:147], v14 offset:864
    s_waitcnt lgkmcnt(5)
    v_mfma_f32_32x32x16_bf16 v[20:35], v[128:131], v[104:107], v[20:35]
    s_waitcnt vmcnt(0)
    s_barrier
    s_lshl_b32 s68, s2, 13
    s_lshl_b32 s69, s28, 11
    s_add_u32 s68, s68, s69
    s_add_u32 s68, s68, 2097152
    v_lshlrev_b32 v195, 4, v1
    v_mov_b32 v196, -1
    v_mov_b32 v197, -1
    v_mov_b32 v198, -1
    v_mov_b32 v199, -1
    buffer_store_dwordx4 v[196:199], v195, s[16:19], s68 offen
    buffer_store_dwordx4 v[196:199], v195, s[16:19], s68 offen offset:1024
    ds_read_b128 v[100:103], v8 offset:49152
    ds_read_b64_tr_b16 v[108:109], v12 offset:12288
    ds_read_b64_tr_b16 v[110:111], v12 offset:12544
    s_waitcnt lgkmcnt(6)
    v_mfma_f32_32x32x16_bf16 v[36:51], v[132:135], v[104:107], v[36:51]
    ds_read_b64_tr_b16 v[112:113], v15 offset:12288
    ds_read_b64_tr_b16 v[114:115], v15 offset:12544
    s_waitcnt lgkmcnt(6)
    v_mfma_f32_32x32x16_bf16 v[52:67], v[136:139], v[104:107], v[52:67]
    ds_read_b64_tr_b16 v[116:117], v13 offset:14336
    ds_read_b64_tr_b16 v[118:119], v13 offset:14464
    s_waitcnt lgkmcnt(8)
    v_mfma_f32_32x32x16_bf16 v[68:83], v[104:107], v[136:139], v[68:83]
    s_waitcnt lgkmcnt(7)
    v_mfma_f32_32x32x16_bf16 v[84:99], v[144:147], v[104:107], v[84:99]
    ds_read_b128 v[124:127], v14 offset:896
    s_waitcnt lgkmcnt(5)
    v_mfma_f32_32x32x16_bf16 v[20:35], v[108:111], v[100:103], v[20:35]
    ds_read_b128 v[104:107], v9 offset:49152
    ds_read_b64_tr_b16 v[128:129], v12 offset:13312
    ds_read_b64_tr_b16 v[130:131], v12 offset:13568
    s_waitcnt lgkmcnt(6)
    v_mfma_f32_32x32x16_bf16 v[36:51], v[112:115], v[100:103], v[36:51]
    ds_read_b64_tr_b16 v[132:133], v15 offset:13312
    ds_read_b64_tr_b16 v[134:135], v15 offset:13568
    s_waitcnt lgkmcnt(6)
    v_mfma_f32_32x32x16_bf16 v[52:67], v[116:119], v[100:103], v[52:67]
    ds_read_b64_tr_b16 v[136:137], v13 offset:14848
    ds_read_b64_tr_b16 v[138:139], v13 offset:14976
    s_waitcnt lgkmcnt(8)
    v_mfma_f32_32x32x16_bf16 v[68:83], v[100:103], v[116:119], v[68:83]
    s_waitcnt lgkmcnt(7)
    v_mfma_f32_32x32x16_bf16 v[84:99], v[124:127], v[100:103], v[84:99]
    ds_read_b128 v[144:147], v14 offset:928
    s_waitcnt lgkmcnt(5)
    v_mfma_f32_32x32x16_bf16 v[20:35], v[128:131], v[104:107], v[20:35]
    ds_read_b128 v[100:103], v10 offset:49152
    ds_read_b64_tr_b16 v[108:109], v12 offset:14336
    ds_read_b64_tr_b16 v[110:111], v12 offset:14592
    s_waitcnt lgkmcnt(6)
    v_mfma_f32_32x32x16_bf16 v[36:51], v[132:135], v[104:107], v[36:51]
    ds_read_b64_tr_b16 v[112:113], v15 offset:14336
    ds_read_b64_tr_b16 v[114:115], v15 offset:14592
    s_waitcnt lgkmcnt(6)
    v_mfma_f32_32x32x16_bf16 v[52:67], v[136:139], v[104:107], v[52:67]
    ds_read_b64_tr_b16 v[116:117], v13 offset:15360
    ds_read_b64_tr_b16 v[118:119], v13 offset:15488
    s_waitcnt lgkmcnt(8)
    v_mfma_f32_32x32x16_bf16 v[68:83], v[104:107], v[136:139], v[68:83]
    s_waitcnt lgkmcnt(7)
    v_mfma_f32_32x32x16_bf16 v[84:99], v[144:147], v[104:107], v[84:99]
    ds_read_b128 v[124:127], v14 offset:960
    s_waitcnt lgkmcnt(5)
    v_mfma_f32_32x32x16_bf16 v[20:35], v[108:111], v[100:103], v[20:35]
    ds_read_b128 v[104:107], v11 offset:49152
    ds_read_b64_tr_b16 v[128:129], v12 offset:15360
    ds_read_b64_tr_b16 v[130:131], v12 offset:15616
    s_waitcnt lgkmcnt(6)
    v_mfma_f32_32x32x16_bf16 v[36:51], v[112:115], v[100:103], v[36:51]
    ds_read_b64_tr_b16 v[132:133], v15 offset:15360
    ds_read_b64_tr_b16 v[134:135], v15 offset:15616
    s_waitcnt lgkmcnt(6)
    v_mfma_f32_32x32x16_bf16 v[52:67], v[116:119], v[100:103], v[52:67]
    ds_read_b64_tr_b16 v[136:137], v13 offset:15872
    ds_read_b64_tr_b16 v[138:139], v13 offset:16000
    s_waitcnt lgkmcnt(8)
    v_mfma_f32_32x32x16_bf16 v[68:83], v[100:103], v[116:119], v[68:83]
    s_waitcnt lgkmcnt(7)
    v_mfma_f32_32x32x16_bf16 v[84:99], v[124:127], v[100:103], v[84:99]
    ds_read_b128 v[144:147], v14 offset:992
    s_waitcnt lgkmcnt(5)
    v_mfma_f32_32x32x16_bf16 v[20:35], v[128:131], v[104:107], v[20:35]
    s_waitcnt lgkmcnt(3)
    v_mfma_f32_32x32x16_bf16 v[36:51], v[132:135], v[104:107], v[36:51]
    s_waitcnt lgkmcnt(1)
    v_mfma_f32_32x32x16_bf16 v[52:67], v[136:139], v[104:107], v[52:67]
    s_waitcnt lgkmcnt(1)
    v_mfma_f32_32x32x16_bf16 v[68:83], v[104:107], v[136:139], v[68:83]
    s_waitcnt lgkmcnt(0)
    v_mfma_f32_32x32x16_bf16 v[84:99], v[144:147], v[104:107], v[84:99]
    s_nop 7
    s_nop 7
    v_lshlrev_b32 v17, 4, v1
    s_mov_b32 s64, 0xbfb8aa3b
    s_mov_b32 s65, 0x3eb8aa3b
    s_lshl_b32 s62, s31, 15
    s_add_u32 s62, s62, 28672
    v_mul_f32 v20, s65, v20
    v_mul_f32 v21, s65, v21
    v_mul_f32 v22, s65, v22
    v_mul_f32 v23, s65, v23
    v_mul_f32 v24, s65, v24
    v_mul_f32 v25, s65, v25
    v_mul_f32 v26, s65, v26
    v_mul_f32 v27, s65, v27
    v_mul_f32 v28, s65, v28
    v_mul_f32 v29, s65, v29
    v_mul_f32 v30, s65, v30
    v_mul_f32 v31, s65, v31
    v_mul_f32 v32, s65, v32
    v_mul_f32 v33, s65, v33
    v_mul_f32 v34, s65, v34
    v_mul_f32 v35, s65, v35
    v_cvt_pk_bf16_f32 v148, v20, v21
    v_cvt_pk_bf16_f32 v149, v22, v23
    v_cvt_pk_bf16_f32 v150, v24, v25
    v_cvt_pk_bf16_f32 v151, v26, v27
    v_cvt_pk_bf16_f32 v152, v28, v29
    v_cvt_pk_bf16_f32 v153, v30, v31
    v_cvt_pk_bf16_f32 v154, v32, v33
    v_cvt_pk_bf16_f32 v155, v34, v35
    buffer_store_dwordx4 v[148:151], v17, s[16:19], s62 offen offset:0
    buffer_store_dwordx4 v[152:155], v17, s[16:19], s62 offen offset:1024
    s_nop 1
    v_mul_f32 v36, s65, v36
    v_mul_f32 v37, s65, v37
    v_mul_f32 v38, s65, v38
    v_mul_f32 v39, s65, v39
    v_mul_f32 v40, s65, v40
    v_mul_f32 v41, s65, v41
    v_mul_f32 v42, s65, v42
    v_mul_f32 v43, s65, v43
    v_mul_f32 v44, s65, v44
    v_mul_f32 v45, s65, v45
    v_mul_f32 v46, s65, v46
    v_mul_f32 v47, s65, v47
    v_mul_f32 v48, s65, v48
    v_mul_f32 v49, s65, v49
    v_mul_f32 v50, s65, v50
    v_mul_f32 v51, s65, v51
    v_cvt_pk_bf16_f32 v148, v36, v37
    v_cvt_pk_bf16_f32 v149, v38, v39
    v_cvt_pk_bf16_f32 v150, v40, v41
    v_cvt_pk_bf16_f32 v151, v42, v43
    v_cvt_pk_bf16_f32 v152, v44, v45
    v_cvt_pk_bf16_f32 v153, v46, v47
    v_cvt_pk_bf16_f32 v154, v48, v49
    v_cvt_pk_bf16_f32 v155, v50, v51
    buffer_store_dwordx4 v[148:151], v17, s[16:19], s62 offen offset:2048
    buffer_store_dwordx4 v[152:155], v17, s[16:19], s62 offen offset:3072
    v_cvt_pk_bf16_f32 v156, v52, v53
    v_cvt_pk_bf16_f32 v157, v54, v55
    v_cvt_pk_bf16_f32 v158, v56, v57
    v_cvt_pk_bf16_f32 v159, v58, v59
    s_lshl_b32 s62, s31, 10
    s_add_u32 s63, s62, 15990784
    buffer_store_dwordx4 v[156:159], v17, s[16:19], s63 offen
    v_cvt_pk_bf16_f32 v160, v68, v69
    v_cvt_pk_bf16_f32 v161, v70, v71
    v_cvt_pk_bf16_f32 v162, v72, v73
    v_cvt_pk_bf16_f32 v163, v74, v75
    v_cvt_pk_bf16_f32 v164, v76, v77
    v_cvt_pk_bf16_f32 v165, v78, v79
    v_cvt_pk_bf16_f32 v166, v80, v81
    v_cvt_pk_bf16_f32 v167, v82, v83
    v_and_b32 v18, 15, v1
    v_lshrrev_b32 v19, 5, v1
    v_lshl_add_u32 v18, v19, 4, v18
    v_lshlrev_b32 v18, 4, v18
    s_add_u32 s63, s62, 16056320
    v_mul_f32 v168, s64, v84
    v_exp_f32 v168, v168
    s_nop 0
    v_add_f32 v168, 1.0, v168
    v_rcp_f32 v168, v168
    v_and_b32 v169, 31, v1
    v_lshlrev_b32 v169, 2, v169
    s_lshl_b32 s62, s31, 7
    s_add_u32 s62, s62, 16121856
    s_mov_b32 exec_lo, 0xffff0000
    s_mov_b32 exec_hi, 0xffff0000
    buffer_store_dwordx4 v[160:163], v18, s[16:19], s63 offen
    buffer_store_dwordx4 v[164:167], v18, s[16:19], s63 offen offset:512
    s_mov_b32 exec_lo, -1
    s_mov_b32 exec_hi, 0
    buffer_store_dword v168, v169, s[16:19], s62 offen
    s_endpgm
L_k1_shuffle:
    s_waitcnt lgkmcnt(0)
    s_mov_b32 s4, s36
    s_mov_b32 s5, s37
    s_mov_b32 s6, 0x200000
    s_mov_b32 s7, 0x00020000
    s_mov_b32 s8, s38
    s_mov_b32 s9, s39
    s_mov_b32 s10, 0x80000
    s_mov_b32 s11, 0x00020000
    s_mov_b32 s16, s56
    s_mov_b32 s17, s57
    s_mov_b32 s18, 0x1000000
    s_mov_b32 s19, 0x00020000
    s_mov_b32 s12, s52
    s_mov_b32 s13, s53
    s_mov_b32 s14, 0x1c0000
    s_mov_b32 s15, 0x00020000
    s_mov_b32 s20, s44
    s_mov_b32 s21, s45
    s_mov_b32 s22, 0x80000
    s_mov_b32 s23, 0x00020000
    v_lshlrev_b32 v17, 4, v1
    s_mul_i32 s32, s29, 114688
    s_mul_i32 s35, s28, 28672
    s_add_u32 s32, s32, s35
    s_mul_i32 s58, s28, 30464
    s_mov_b32 m0, s58
    s_nop 0
    buffer_load_dwordx4 v17, s[12:15], s32 offen lds
    s_add_u32 m0, s58, 1088
    s_add_u32 s61, s32, 1024
    buffer_load_dwordx4 v17, s[12:15], s61 offen lds
    s_add_u32 m0, s58, 2176
    s_add_u32 s61, s32, 2048
    buffer_load_dwordx4 v17, s[12:15], s61 offen lds
    s_add_u32 m0, s58, 3264
    s_add_u32 s61, s32, 3072
    buffer_load_dwordx4 v17, s[12:15], s61 offen lds
    s_add_u32 m0, s58, 4352
    s_add_u32 s61, s32, 4096
    buffer_load_dwordx4 v17, s[12:15], s61 offen lds
    s_add_u32 m0, s58, 5440
    s_add_u32 s61, s32, 5120
    buffer_load_dwordx4 v17, s[12:15], s61 offen lds
    s_add_u32 m0, s58, 6528
    s_add_u32 s61, s32, 6144
    buffer_load_dwordx4 v17, s[12:15], s61 offen lds
    s_add_u32 m0, s58, 7616
    s_add_u32 s61, s32, 7168
    buffer_load_dwordx4 v17, s[12:15], s61 offen lds
    s_add_u32 m0, s58, 8704
    s_add_u32 s61, s32, 8192
    buffer_load_dwordx4 v17, s[12:15], s61 offen lds
    s_add_u32 m0, s58, 9792
    s_add_u32 s61, s32, 9216
    buffer_load_dwordx4 v17, s[12:15], s61 offen lds
    s_add_u32 m0, s58, 10880
    s_add_u32 s61, s32, 10240
    buffer_load_dwordx4 v17, s[12:15], s61 offen lds
    s_add_u32 m0, s58, 11968
    s_add_u32 s61, s32, 11264
    buffer_load_dwordx4 v17, s[12:15], s61 offen lds
    s_add_u32 m0, s58, 13056
    s_add_u32 s61, s32, 12288
    buffer_load_dwordx4 v17, s[12:15], s61 offen lds
    s_add_u32 m0, s58, 14144
    s_add_u32 s61, s32, 13312
    buffer_load_dwordx4 v17, s[12:15], s61 offen lds
    s_add_u32 m0, s58, 15232
    s_add_u32 s61, s32, 14336
    buffer_load_dwordx4 v17, s[12:15], s61 offen lds
    s_add_u32 m0, s58, 16320
    s_add_u32 s61, s32, 15360
    buffer_load_dwordx4 v17, s[12:15], s61 offen lds
    s_add_u32 m0, s58, 17408
    s_add_u32 s61, s32, 16384
    buffer_load_dwordx4 v17, s[12:15], s61 offen lds
    s_add_u32 m0, s58, 18496
    s_add_u32 s61, s32, 17408
    buffer_load_dwordx4 v17, s[12:15], s61 offen lds
    s_add_u32 m0, s58, 19584
    s_add_u32 s61, s32, 18432
    buffer_load_dwordx4 v17, s[12:15], s61 offen lds
    s_add_u32 m0, s58, 20672
    s_add_u32 s61, s32, 19456
    buffer_load_dwordx4 v17, s[12:15], s61 offen lds
    s_add_u32 m0, s58, 21760
    s_add_u32 s61, s32, 20480
    buffer_load_dwordx4 v17, s[12:15], s61 offen lds
    s_add_u32 m0, s58, 22848
    s_add_u32 s61, s32, 21504
    buffer_load_dwordx4 v17, s[12:15], s61 offen lds
    s_add_u32 m0, s58, 23936
    s_add_u32 s61, s32, 22528
    buffer_load_dwordx4 v17, s[12:15], s61 offen lds
    s_add_u32 m0, s58, 25024
    s_add_u32 s61, s32, 23552
    buffer_load_dwordx4 v17, s[12:15], s61 offen lds
    s_add_u32 m0, s58, 26112
    s_add_u32 s61, s32, 24576
    buffer_load_dwordx4 v17, s[12:15], s61 offen lds
    s_add_u32 m0, s58, 27200
    s_add_u32 s61, s32, 25600
    buffer_load_dwordx4 v17, s[12:15], s61 offen lds
    s_add_u32 m0, s58, 28288
    s_add_u32 s61, s32, 26624
    buffer_load_dwordx4 v17, s[12:15], s61 offen lds
    s_add_u32 m0, s58, 29376
    s_add_u32 s61, s32, 27648
    buffer_load_dwordx4 v17, s[12:15], s61 offen lds
    s_lshl_b32 s33, s29, 15
    s_lshl_b32 s35, s28, 13
    s_add_u32 s33, s33, s35
    s_mul_i32 s59, s28, 8704
    s_add_u32 s59, s59, 121856
    s_mov_b32 m0, s59
    s_nop 0
    buffer_load_dwordx4 v17, s[20:23], s33 offen lds
    s_add_u32 m0, s59, 1088
    s_add_u32 s61, s33, 1024
    buffer_load_dwordx4 v17, s[20:23], s61 offen lds
    s_add_u32 m0, s59, 2176
    s_add_u32 s61, s33, 2048
    buffer_load_dwordx4 v17, s[20:23], s61 offen lds
    s_add_u32 m0, s59, 3264
    s_add_u32 s61, s33, 3072
    buffer_load_dwordx4 v17, s[20:23], s61 offen lds
    s_add_u32 m0, s59, 4352
    s_add_u32 s61, s33, 4096
    buffer_load_dwordx4 v17, s[20:23], s61 offen lds
    s_add_u32 m0, s59, 5440
    s_add_u32 s61, s33, 5120
    buffer_load_dwordx4 v17, s[20:23], s61 offen lds
    s_add_u32 m0, s59, 6528
    s_add_u32 s61, s33, 6144
    buffer_load_dwordx4 v17, s[20:23], s61 offen lds
    s_add_u32 m0, s59, 7616
    s_add_u32 s61, s33, 7168
    buffer_load_dwordx4 v17, s[20:23], s61 offen lds
    v_lshrrev_b32 v2, 5, v1
    v_lshlrev_b32 v2, 2, v2
    v_bfe_u32 v3, v1, 2, 2
    v_add_u32 v2, v2, v3
    v_mul_u32_u24 v2, 1088, v2
    v_and_b32 v3, 1, v1
    v_lshl_add_u32 v2, v3, 5, v2
    v_bfe_u32 v3, v1, 4, 1
    v_lshl_add_u32 v2, v3, 4, v2
    v_bfe_u32 v3, v1, 1, 1
    v_lshl_add_u32 v2, v3, 3, v2
    s_lshl_b32 s35, s28, 8
    v_add_u32 v2, s35, v2
    v_add_u32 v3, 69632, v2
    v_add_u32 v4, 139264, v2
    s_mul_i32 s34, s28, 458752
    s_mul_i32 s35, s29, 7168
    s_add_u32 s34, s34, s35
    s_add_u32 s34, s34, 13631488
    s_lshl_b32 s60, s28, 17
    s_lshl_b32 s35, s29, 11
    s_add_u32 s60, s60, s35
    s_add_u32 s60, s60, 15466496
    s_waitcnt vmcnt(0)
    s_barrier
    s_lshl_b32 s68, s2, 13
    s_lshl_b32 s69, s28, 11
    s_add_u32 s68, s68, s69
    s_add_u32 s68, s68, 2097152
    v_lshlrev_b32 v195, 4, v1
    v_mov_b32 v196, -1
    v_mov_b32 v197, -1
    v_mov_b32 v198, -1
    v_mov_b32 v199, -1
    buffer_store_dwordx4 v[196:199], v195, s[16:19], s68 offen
    buffer_store_dwordx4 v[196:199], v195, s[16:19], s68 offen offset:1024
    ds_read_b64_tr_b16 v[20:21], v2 offset:0
    ds_read_b64_tr_b16 v[22:23], v2 offset:8704
    ds_read_b64_tr_b16 v[24:25], v2 offset:17408
    ds_read_b64_tr_b16 v[26:27], v2 offset:26112
    ds_read_b64_tr_b16 v[28:29], v2 offset:34816
    ds_read_b64_tr_b16 v[30:31], v2 offset:43520
    ds_read_b64_tr_b16 v[32:33], v2 offset:52224
    ds_read_b64_tr_b16 v[34:35], v2 offset:60928
    ds_read_b64_tr_b16 v[36:37], v3 offset:0
    ds_read_b64_tr_b16 v[38:39], v3 offset:8704
    ds_read_b64_tr_b16 v[40:41], v3 offset:17408
    ds_read_b64_tr_b16 v[42:43], v3 offset:26112
    s_waitcnt lgkmcnt(0)
    s_add_u32 s61, s34, 0
    buffer_store_dwordx4 v[20:23], v17, s[16:19], s61 offen
    s_add_u32 s61, s34, 1024
    buffer_store_dwordx4 v[24:27], v17, s[16:19], s61 offen
    s_add_u32 s61, s34, 2048
    buffer_store_dwordx4 v[28:31], v17, s[16:19], s61 offen
    s_add_u32 s61, s34, 3072
    buffer_store_dwordx4 v[32:35], v17, s[16:19], s61 offen
    s_add_u32 s61, s34, 4096
    buffer_store_dwordx4 v[36:39], v17, s[16:19], s61 offen
    s_add_u32 s61, s34, 5120
    buffer_store_dwordx4 v[40:43], v17, s[16:19], s61 offen
    ds_read_b64_tr_b16 v[44:45], v3 offset:34816
    ds_read_b64_tr_b16 v[46:47], v3 offset:43520
    ds_read_b64_tr_b16 v[48:49], v3 offset:52224
    ds_read_b64_tr_b16 v[50:51], v3 offset:60928
    ds_read_b64_tr_b16 v[52:53], v4 offset:0
    ds_read_b64_tr_b16 v[54:55], v4 offset:8704
    ds_read_b64_tr_b16 v[56:57], v2 offset:64
    ds_read_b64_tr_b16 v[58:59], v2 offset:8768
    ds_read_b64_tr_b16 v[60:61], v2 offset:17472
    ds_read_b64_tr_b16 v[62:63], v2 offset:26176
    ds_read_b64_tr_b16 v[64:65], v2 offset:34880
    ds_read_b64_tr_b16 v[66:67], v2 offset:43584
    s_waitcnt lgkmcnt(0)
    s_add_u32 s61, s34, 6144
    buffer_store_dwordx4 v[44:47], v17, s[16:19], s61 offen
    s_add_u32 s61, s60, 0
    buffer_store_dwordx4 v[48:51], v17, s[16:19], s61 offen
    s_add_u32 s61, s60, 1024
    buffer_store_dwordx4 v[52:55], v17, s[16:19], s61 offen
    s_add_u32 s61, s34, 114688
    buffer_store_dwordx4 v[56:59], v17, s[16:19], s61 offen
    s_add_u32 s61, s34, 115712
    buffer_store_dwordx4 v[60:63], v17, s[16:19], s61 offen
    s_add_u32 s61, s34, 116736
    buffer_store_dwordx4 v[64:67], v17, s[16:19], s61 offen
    ds_read_b64_tr_b16 v[68:69], v2 offset:52288
    ds_read_b64_tr_b16 v[70:71], v2 offset:60992
    ds_read_b64_tr_b16 v[72:73], v3 offset:64
    ds_read_b64_tr_b16 v[74:75], v3 offset:8768
    ds_read_b64_tr_b16 v[76:77], v3 offset:17472
    ds_read_b64_tr_b16 v[78:79], v3 offset:26176
    ds_read_b64_tr_b16 v[80:81], v3 offset:34880
    ds_read_b64_tr_b16 v[82:83], v3 offset:43584
    ds_read_b64_tr_b16 v[84:85], v3 offset:52288
    ds_read_b64_tr_b16 v[86:87], v3 offset:60992
    ds_read_b64_tr_b16 v[88:89], v4 offset:64
    ds_read_b64_tr_b16 v[90:91], v4 offset:8768
    s_waitcnt lgkmcnt(0)
    s_add_u32 s61, s34, 117760
    buffer_store_dwordx4 v[68:71], v17, s[16:19], s61 offen
    s_add_u32 s61, s34, 118784
    buffer_store_dwordx4 v[72:75], v17, s[16:19], s61 offen
    s_add_u32 s61, s34, 119808
    buffer_store_dwordx4 v[76:79], v17, s[16:19], s61 offen
    s_add_u32 s61, s34, 120832
    buffer_store_dwordx4 v[80:83], v17, s[16:19], s61 offen
    s_add_u32 s61, s60, 32768
    buffer_store_dwordx4 v[84:87], v17, s[16:19], s61 offen
    s_add_u32 s61, s60, 33792
    buffer_store_dwordx4 v[88:91], v17, s[16:19], s61 offen
    ds_read_b64_tr_b16 v[92:93], v2 offset:128
    ds_read_b64_tr_b16 v[94:95], v2 offset:8832
    ds_read_b64_tr_b16 v[96:97], v2 offset:17536
    ds_read_b64_tr_b16 v[98:99], v2 offset:26240
    ds_read_b64_tr_b16 v[100:101], v2 offset:34944
    ds_read_b64_tr_b16 v[102:103], v2 offset:43648
    ds_read_b64_tr_b16 v[104:105], v2 offset:52352
    ds_read_b64_tr_b16 v[106:107], v2 offset:61056
    ds_read_b64_tr_b16 v[108:109], v3 offset:128
    ds_read_b64_tr_b16 v[110:111], v3 offset:8832
    ds_read_b64_tr_b16 v[112:113], v3 offset:17536
    ds_read_b64_tr_b16 v[114:115], v3 offset:26240
    s_waitcnt lgkmcnt(0)
    s_add_u32 s61, s34, 229376
    buffer_store_dwordx4 v[92:95], v17, s[16:19], s61 offen
    s_add_u32 s61, s34, 230400
    buffer_store_dwordx4 v[96:99], v17, s[16:19], s61 offen
    s_add_u32 s61, s34, 231424
    buffer_store_dwordx4 v[100:103], v17, s[16:19], s61 offen
    s_add_u32 s61, s34, 232448
    buffer_store_dwordx4 v[104:107], v17, s[16:19], s61 offen
    s_add_u32 s61, s34, 233472
    buffer_store_dwordx4 v[108:111], v17, s[16:19], s61 offen
    s_add_u32 s61, s34, 234496
    buffer_store_dwordx4 v[112:115], v17, s[16:19], s61 offen
    ds_read_b64_tr_b16 v[116:117], v3 offset:34944
    ds_read_b64_tr_b16 v[118:119], v3 offset:43648
    ds_read_b64_tr_b16 v[120:121], v3 offset:52352
    ds_read_b64_tr_b16 v[122:123], v3 offset:61056
    ds_read_b64_tr_b16 v[124:125], v4 offset:128
    ds_read_b64_tr_b16 v[126:127], v4 offset:8832
    ds_read_b64_tr_b16 v[128:129], v2 offset:192
    ds_read_b64_tr_b16 v[130:131], v2 offset:8896
    ds_read_b64_tr_b16 v[132:133], v2 offset:17600
    ds_read_b64_tr_b16 v[134:135], v2 offset:26304
    ds_read_b64_tr_b16 v[136:137], v2 offset:35008
    ds_read_b64_tr_b16 v[138:139], v2 offset:43712
    s_waitcnt lgkmcnt(0)
    s_add_u32 s61, s34, 235520
    buffer_store_dwordx4 v[116:119], v17, s[16:19], s61 offen
    s_add_u32 s61, s60, 65536
    buffer_store_dwordx4 v[120:123], v17, s[16:19], s61 offen
    s_add_u32 s61, s60, 66560
    buffer_store_dwordx4 v[124:127], v17, s[16:19], s61 offen
    s_add_u32 s61, s34, 344064
    buffer_store_dwordx4 v[128:131], v17, s[16:19], s61 offen
    s_add_u32 s61, s34, 345088
    buffer_store_dwordx4 v[132:135], v17, s[16:19], s61 offen
    s_add_u32 s61, s34, 346112
    buffer_store_dwordx4 v[136:139], v17, s[16:19], s61 offen
    ds_read_b64_tr_b16 v[140:141], v2 offset:52416
    ds_read_b64_tr_b16 v[142:143], v2 offset:61120
    ds_read_b64_tr_b16 v[144:145], v3 offset:192
    ds_read_b64_tr_b16 v[146:147], v3 offset:8896
    ds_read_b64_tr_b16 v[148:149], v3 offset:17600
    ds_read_b64_tr_b16 v[150:151], v3 offset:26304
    ds_read_b64_tr_b16 v[152:153], v3 offset:35008
    ds_read_b64_tr_b16 v[154:155], v3 offset:43712
    ds_read_b64_tr_b16 v[156:157], v3 offset:52416
    ds_read_b64_tr_b16 v[158:159], v3 offset:61120
    ds_read_b64_tr_b16 v[160:161], v4 offset:192
    ds_read_b64_tr_b16 v[162:163], v4 offset:8896
    s_waitcnt lgkmcnt(0)
    s_add_u32 s61, s34, 347136
    buffer_store_dwordx4 v[140:143], v17, s[16:19], s61 offen
    s_add_u32 s61, s34, 348160
    buffer_store_dwordx4 v[144:147], v17, s[16:19], s61 offen
    s_add_u32 s61, s34, 349184
    buffer_store_dwordx4 v[148:151], v17, s[16:19], s61 offen
    s_add_u32 s61, s34, 350208
    buffer_store_dwordx4 v[152:155], v17, s[16:19], s61 offen
    s_add_u32 s61, s60, 98304
    buffer_store_dwordx4 v[156:159], v17, s[16:19], s61 offen
    s_add_u32 s61, s60, 99328
    buffer_store_dwordx4 v[160:163], v17, s[16:19], s61 offen
    s_endpgm
L_k1_end:
    s_endpgm
.globl gm_k2_kernel
.p2align 8
.type gm_k2_kernel,@function
gm_k2_kernel:
    s_cmp_ge_u32 s2, 256
    s_cbranch_scc1 L_k2_end
    s_load_dwordx2 s[18:19], s[0:1], 96
    s_load_dwordx2 s[26:27], s[0:1], 80
    v_and_b32 v1, 63, v0
    v_lshrrev_b32 v2, 6, v0
    s_and_b32 s3, s2, 7
    s_lshr_b32 s11, s2, 3
    s_and_b32 s10, s11, 7
    s_lshr_b32 s11, s11, 3
    s_lshl_b32 s3, s3, 2
    s_add_u32 s9, s3, s11
    v_readfirstlane_b32 s8, v2
    v_lshlrev_b32 v4, 4, v1
    s_waitcnt lgkmcnt(0)
    s_mov_b32 s4, s18
    s_mov_b32 s5, s19
    s_mov_b32 s6, 0x1000000
    s_mov_b32 s7, 0x00020000
    s_cmp_ge_u32 s8, 4
    s_cbranch_scc1 L_k2_ffn
L_k2_attn:
    s_setprio 2
    s_lshl_b32 s11, s10, 2
    s_add_u32 s11, s11, s8
    s_lshl_b32 s11, s11, 10
    s_lshl_b32 s16, s9, 16
    s_add_u32 s17, s11, s16
    s_add_u32 s16, s17, 32768
    buffer_load_dwordx4 v[12:15], v4, s[4:7], s17 offen
    buffer_load_dwordx4 v[16:19], v4, s[4:7], s16 offen
    s_lshl_b32 s20, s8, 10
    s_add_u32 s21, s20, 15990784
    s_mov_b32 m0, s20
    s_add_u32 s22, s21, 0
    buffer_load_dwordx4 v4, s[4:7], s22 offen lds
    s_add_u32 m0, s20, 65536
    s_add_u32 s22, s21, 65536
    buffer_load_dwordx4 v4, s[4:7], s22 offen lds
    s_mov_b32 s12, 0x0000ffff
    s_mov_b32 s13, 0x0000ffff
    v_and_b32 v5, 27, v1
    v_cmp_eq_u32 vcc, 16, v5
    v_mov_b32 v6, 0x3f803f80
    v_cndmask_b32 v5, 0, v6, vcc
    v_mov_b32 v28, v5
    v_mov_b32 v29, v5
    v_mov_b32 v30, v5
    v_mov_b32 v31, v5
    v_mov_b32 v32, v5
    v_mov_b32 v33, v5
    v_mov_b32 v34, v5
    v_mov_b32 v35, v5
    v_mov_b32 v36, v5
    v_mov_b32 v37, v5
    v_mov_b32 v38, v5
    v_mov_b32 v39, v5
    v_mov_b32 v40, v5
    v_mov_b32 v41, v5
    v_mov_b32 v42, v5
    v_mov_b32 v43, v5
    v_mov_b32 v44, 0
    v_mov_b32 v45, 0
    v_mov_b32 v46, 0
    v_mov_b32 v47, 0
    v_mov_b32 v48, 0
    v_mov_b32 v49, 0
    v_mov_b32 v50, 0
    v_mov_b32 v51, 0
    v_mov_b32 v84, 0
    v_mov_b32 v100, 0
    v_mov_b32 v85, 0
    v_mov_b32 v101, 0
    v_mov_b32 v86, 0
    v_mov_b32 v102, 0
    v_mov_b32 v87, 0
    v_mov_b32 v103, 0
    v_mov_b32 v88, 0
    v_mov_b32 v104, 0
    v_mov_b32 v89, 0
    v_mov_b32 v105, 0
    v_mov_b32 v90, 0
    v_mov_b32 v106, 0
    v_mov_b32 v91, 0
    v_mov_b32 v107, 0
    v_mov_b32 v92, 0
    v_mov_b32 v108, 0
    v_mov_b32 v93, 0
    v_mov_b32 v109, 0
    v_mov_b32 v94, 0
    v_mov_b32 v110, 0
    v_mov_b32 v95, 0
    v_mov_b32 v111, 0
    v_mov_b32 v96, 0
    v_mov_b32 v112, 0
    v_mov_b32 v97, 0
    v_mov_b32 v113, 0
    v_mov_b32 v98, 0
    v_mov_b32 v114, 0
    v_mov_b32 v99, 0
    v_mov_b32 v115, 0
    v_mov_b32 v82, 0
    v_mov_b32 v83, 0
    v_lshlrev_b32 v2, 4, v1
    v_and_b32 v3, 15, v1
    v_lshrrev_b32 v5, 5, v1
    v_lshl_add_u32 v3, v5, 4, v3
    v_lshlrev_b32 v3, 4, v3
    v_add_u32 v3, 0x10000, v3
    s_mov_b32 s14, 0
    s_mov_b32 s15, 97
    s_waitcnt vmcnt(0)
    s_barrier
    ds_read_b128 v[20:23], v2
    s_mov_b64 exec, s[12:13]
    ds_read_b128 v[28:31], v3
    ds_read_b128 v[32:35], v3 offset:512
    s_mov_b64 exec, -1
    s_waitcnt lgkmcnt(0)
    v_mfma_f32_32x32x16_bf16 v[52:67], v[20:23], v[12:15], 0
    s_nop 7
    s_nop 7
L_k2_loop:
    v_exp_f32 v52, v52
    v_exp_f32 v53, v53
    v_cvt_pk_bf16_f32 v51, v82, v83
    v_mfma_f32_32x32x16_bf16 v[68:83], v[20:23], v[16:19], 0
    v_exp_f32 v54, v54
    v_exp_f32 v55, v55
    v_cvt_pk_bf16_f32 v44, v52, v53
    v_exp_f32 v56, v56
    v_exp_f32 v57, v57
    v_cvt_pk_bf16_f32 v45, v54, v55
    v_mfma_f32_32x32x16_bf16 v[100:115], v[40:43], v[48:51], v[100:115]
    ds_read_b128 v[24:27], v2 offset:1024
    s_mov_b64 exec, s[12:13]
    ds_read_b128 v[36:39], v3 offset:1024
    ds_read_b128 v[40:43], v3 offset:1536
    s_mov_b64 exec, -1
    v_exp_f32 v58, v58
    v_exp_f32 v59, v59
    v_cvt_pk_bf16_f32 v46, v56, v57
    v_exp_f32 v60, v60
    v_exp_f32 v61, v61
    v_cvt_pk_bf16_f32 v47, v58, v59
    v_exp_f32 v62, v62
    v_exp_f32 v63, v63
    v_mfma_f32_32x32x16_bf16 v[84:99], v[28:31], v[44:47], v[84:99]
    v_cvt_pk_bf16_f32 v48, v60, v61
    v_exp_f32 v64, v64
    v_exp_f32 v65, v65
    v_cvt_pk_bf16_f32 v49, v62, v63
    v_exp_f32 v66, v66
    v_exp_f32 v67, v67
    v_cvt_pk_bf16_f32 v50, v64, v65
    v_exp_f32 v68, v68
    v_exp_f32 v69, v69
    v_cvt_pk_bf16_f32 v51, v66, v67
    s_waitcnt lgkmcnt(0)
    v_mfma_f32_32x32x16_bf16 v[52:67], v[24:27], v[12:15], 0
    v_exp_f32 v70, v70
    v_exp_f32 v71, v71
    v_cvt_pk_bf16_f32 v44, v68, v69
    v_exp_f32 v72, v72
    v_exp_f32 v73, v73
    v_cvt_pk_bf16_f32 v45, v70, v71
    v_mfma_f32_32x32x16_bf16 v[84:99], v[32:35], v[48:51], v[84:99]
    v_exp_f32 v74, v74
    v_exp_f32 v75, v75
    v_cvt_pk_bf16_f32 v46, v72, v73
    v_exp_f32 v76, v76
    v_exp_f32 v77, v77
    v_cvt_pk_bf16_f32 v47, v74, v75
    v_exp_f32 v78, v78
    v_exp_f32 v79, v79
    v_mfma_f32_32x32x16_bf16 v[100:115], v[28:31], v[44:47], v[100:115]
    v_cvt_pk_bf16_f32 v48, v76, v77
    v_exp_f32 v80, v80
    v_exp_f32 v81, v81
    v_cvt_pk_bf16_f32 v49, v78, v79
    v_exp_f32 v82, v82
    v_exp_f32 v83, v83
    v_cvt_pk_bf16_f32 v50, v80, v81
    v_exp_f32 v52, v52
    v_exp_f32 v53, v53
    v_cvt_pk_bf16_f32 v51, v82, v83
    v_mfma_f32_32x32x16_bf16 v[68:83], v[24:27], v[16:19], 0
    v_exp_f32 v54, v54
    v_exp_f32 v55, v55
    v_cvt_pk_bf16_f32 v44, v52, v53
    v_exp_f32 v56, v56
    v_exp_f32 v57, v57
    v_cvt_pk_bf16_f32 v45, v54, v55
    v_mfma_f32_32x32x16_bf16 v[100:115], v[32:35], v[48:51], v[100:115]
    ds_read_b128 v[20:23], v2 offset:2048
    s_mov_b64 exec, s[12:13]
    ds_read_b128 v[28:31], v3 offset:2048
    ds_read_b128 v[32:35], v3 offset:2560
    s_mov_b64 exec, -1
    v_exp_f32 v58, v58
    v_exp_f32 v59, v59
    v_cvt_pk_bf16_f32 v46, v56, v57
    v_exp_f32 v60, v60
    v_exp_f32 v61, v61
    v_cvt_pk_bf16_f32 v47, v58, v59
    v_exp_f32 v62, v62
    v_exp_f32 v63, v63
    v_mfma_f32_32x32x16_bf16 v[84:99], v[36:39], v[44:47], v[84:99]
    v_cvt_pk_bf16_f32 v48, v60, v61
    v_exp_f32 v64, v64
    v_exp_f32 v65, v65
    v_cvt_pk_bf16_f32 v49, v62, v63
    v_exp_f32 v66, v66
    v_exp_f32 v67, v67
    v_cvt_pk_bf16_f32 v50, v64, v65
    v_exp_f32 v68, v68
    v_exp_f32 v69, v69
    v_cvt_pk_bf16_f32 v51, v66, v67
    s_waitcnt lgkmcnt(0)
    v_mfma_f32_32x32x16_bf16 v[52:67], v[20:23], v[12:15], 0
    v_exp_f32 v70, v70
    v_exp_f32 v71, v71
    v_cvt_pk_bf16_f32 v44, v68, v69
    v_exp_f32 v72, v72
    v_exp_f32 v73, v73
    v_cvt_pk_bf16_f32 v45, v70, v71
    v_mfma_f32_32x32x16_bf16 v[84:99], v[40:43], v[48:51], v[84:99]
    v_exp_f32 v74, v74
    v_exp_f32 v75, v75
    v_cvt_pk_bf16_f32 v46, v72, v73
    v_exp_f32 v76, v76
    v_exp_f32 v77, v77
    v_cvt_pk_bf16_f32 v47, v74, v75
    v_exp_f32 v78, v78
    v_exp_f32 v79, v79
    v_mfma_f32_32x32x16_bf16 v[100:115], v[36:39], v[44:47], v[100:115]
    v_cvt_pk_bf16_f32 v48, v76, v77
    v_exp_f32 v80, v80
    v_exp_f32 v81, v81
    v_cvt_pk_bf16_f32 v49, v78, v79
    v_exp_f32 v82, v82
    v_exp_f32 v83, v83
    v_cvt_pk_bf16_f32 v50, v80, v81
    v_exp_f32 v52, v52
    v_exp_f32 v53, v53
    v_cvt_pk_bf16_f32 v51, v82, v83
    v_mfma_f32_32x32x16_bf16 v[68:83], v[20:23], v[16:19], 0
    v_exp_f32 v54, v54
    v_exp_f32 v55, v55
    v_cvt_pk_bf16_f32 v44, v52, v53
    v_exp_f32 v56, v56
    v_exp_f32 v57, v57
    v_cvt_pk_bf16_f32 v45, v54, v55
    v_mfma_f32_32x32x16_bf16 v[100:115], v[40:43], v[48:51], v[100:115]
    ds_read_b128 v[24:27], v2 offset:3072
    s_mov_b64 exec, s[12:13]
    ds_read_b128 v[36:39], v3 offset:3072
    ds_read_b128 v[40:43], v3 offset:3584
    s_mov_b64 exec, -1
    v_exp_f32 v58, v58
    v_exp_f32 v59, v59
    v_cvt_pk_bf16_f32 v46, v56, v57
    v_exp_f32 v60, v60
    v_exp_f32 v61, v61
    v_cvt_pk_bf16_f32 v47, v58, v59
    v_exp_f32 v62, v62
    v_exp_f32 v63, v63
    v_mfma_f32_32x32x16_bf16 v[84:99], v[28:31], v[44:47], v[84:99]
    v_cvt_pk_bf16_f32 v48, v60, v61
    v_exp_f32 v64, v64
    v_exp_f32 v65, v65
    v_cvt_pk_bf16_f32 v49, v62, v63
    v_exp_f32 v66, v66
    v_exp_f32 v67, v67
    v_cvt_pk_bf16_f32 v50, v64, v65
    v_exp_f32 v68, v68
    v_exp_f32 v69, v69
    v_cvt_pk_bf16_f32 v51, v66, v67
    s_waitcnt lgkmcnt(0)
    v_mfma_f32_32x32x16_bf16 v[52:67], v[24:27], v[12:15], 0
    v_exp_f32 v70, v70
    v_exp_f32 v71, v71
    v_cvt_pk_bf16_f32 v44, v68, v69
    v_exp_f32 v72, v72
    v_exp_f32 v73, v73
    v_cvt_pk_bf16_f32 v45, v70, v71
    v_mfma_f32_32x32x16_bf16 v[84:99], v[32:35], v[48:51], v[84:99]
    v_exp_f32 v74, v74
    v_exp_f32 v75, v75
    v_cvt_pk_bf16_f32 v46, v72, v73
    v_exp_f32 v76, v76
    v_exp_f32 v77, v77
    v_cvt_pk_bf16_f32 v47, v74, v75
    v_exp_f32 v78, v78
    v_exp_f32 v79, v79
    v_mfma_f32_32x32x16_bf16 v[100:115], v[28:31], v[44:47], v[100:115]
    v_cvt_pk_bf16_f32 v48, v76, v77
    v_exp_f32 v80, v80
    v_exp_f32 v81, v81
    v_cvt_pk_bf16_f32 v49, v78, v79
    v_exp_f32 v82, v82
    v_exp_f32 v83, v83
    v_cvt_pk_bf16_f32 v50, v80, v81
    v_exp_f32 v52, v52
    v_exp_f32 v53, v53
    v_cvt_pk_bf16_f32 v51, v82, v83
    v_mfma_f32_32x32x16_bf16 v[68:83], v[24:27], v[16:19], 0
    v_exp_f32 v54, v54
    v_exp_f32 v55, v55
    v_cvt_pk_bf16_f32 v44, v52, v53
    v_exp_f32 v56, v56
    v_exp_f32 v57, v57
    v_cvt_pk_bf16_f32 v45, v54, v55
    v_mfma_f32_32x32x16_bf16 v[100:115], v[32:35], v[48:51], v[100:115]
    ds_read_b128 v[20:23], v2 offset:4096
    s_mov_b64 exec, s[12:13]
    ds_read_b128 v[28:31], v3 offset:4096
    ds_read_b128 v[32:35], v3 offset:4608
    s_mov_b64 exec, -1
    v_exp_f32 v58, v58
    v_exp_f32 v59, v59
    v_cvt_pk_bf16_f32 v46, v56, v57
    v_exp_f32 v60, v60
    v_exp_f32 v61, v61
    v_cvt_pk_bf16_f32 v47, v58, v59
    v_exp_f32 v62, v62
    v_exp_f32 v63, v63
    v_mfma_f32_32x32x16_bf16 v[84:99], v[36:39], v[44:47], v[84:99]
    v_cvt_pk_bf16_f32 v48, v60, v61
    v_exp_f32 v64, v64
    v_exp_f32 v65, v65
    v_cvt_pk_bf16_f32 v49, v62, v63
    v_exp_f32 v66, v66
    v_exp_f32 v67, v67
    v_cvt_pk_bf16_f32 v50, v64, v65
    v_exp_f32 v68, v68
    v_exp_f32 v69, v69
    v_cvt_pk_bf16_f32 v51, v66, v67
    s_waitcnt lgkmcnt(0)
    v_mfma_f32_32x32x16_bf16 v[52:67], v[20:23], v[12:15], 0
    v_exp_f32 v70, v70
    v_exp_f32 v71, v71
    v_cvt_pk_bf16_f32 v44, v68, v69
    v_exp_f32 v72, v72
    v_exp_f32 v73, v73
    v_cvt_pk_bf16_f32 v45, v70, v71
    v_mfma_f32_32x32x16_bf16 v[84:99], v[40:43], v[48:51], v[84:99]
    v_exp_f32 v74, v74
    v_exp_f32 v75, v75
    v_cvt_pk_bf16_f32 v46, v72, v73
    v_exp_f32 v76, v76
    v_exp_f32 v77, v77
    v_cvt_pk_bf16_f32 v47, v74, v75
    v_exp_f32 v78, v78
    v_exp_f32 v79, v79
    v_mfma_f32_32x32x16_bf16 v[100:115], v[36:39], v[44:47], v[100:115]
    v_cvt_pk_bf16_f32 v48, v76, v77
    v_exp_f32 v80, v80
    v_exp_f32 v81, v81
    v_cvt_pk_bf16_f32 v49, v78, v79
    v_exp_f32 v82, v82
    v_exp_f32 v83, v83
    v_cvt_pk_bf16_f32 v50, v80, v81
    v_exp_f32 v52, v52
    v_exp_f32 v53, v53
    v_cvt_pk_bf16_f32 v51, v82, v83
    v_mfma_f32_32x32x16_bf16 v[68:83], v[20:23], v[16:19], 0
    v_exp_f32 v54, v54
    v_exp_f32 v55, v55
    v_cvt_pk_bf16_f32 v44, v52, v53
    v_exp_f32 v56, v56
    v_exp_f32 v57, v57
    v_cvt_pk_bf16_f32 v45, v54, v55
    v_mfma_f32_32x32x16_bf16 v[100:115], v[40:43], v[48:51], v[100:115]
    ds_read_b128 v[24:27], v2 offset:5120
    s_mov_b64 exec, s[12:13]
    ds_read_b128 v[36:39], v3 offset:5120
    ds_read_b128 v[40:43], v3 offset:5632
    s_mov_b64 exec, -1
    v_exp_f32 v58, v58
    v_exp_f32 v59, v59
    v_cvt_pk_bf16_f32 v46, v56, v57
    v_exp_f32 v60, v60
    v_exp_f32 v61, v61
    v_cvt_pk_bf16_f32 v47, v58, v59
    v_exp_f32 v62, v62
    v_exp_f32 v63, v63
    v_mfma_f32_32x32x16_bf16 v[84:99], v[28:31], v[44:47], v[84:99]
    v_cvt_pk_bf16_f32 v48, v60, v61
    v_exp_f32 v64, v64
    v_exp_f32 v65, v65
    v_cvt_pk_bf16_f32 v49, v62, v63
    v_exp_f32 v66, v66
    v_exp_f32 v67, v67
    v_cvt_pk_bf16_f32 v50, v64, v65
    v_exp_f32 v68, v68
    v_exp_f32 v69, v69
    v_cvt_pk_bf16_f32 v51, v66, v67
    s_waitcnt lgkmcnt(0)
    v_mfma_f32_32x32x16_bf16 v[52:67], v[24:27], v[12:15], 0
    v_exp_f32 v70, v70
    v_exp_f32 v71, v71
    v_cvt_pk_bf16_f32 v44, v68, v69
    v_exp_f32 v72, v72
    v_exp_f32 v73, v73
    v_cvt_pk_bf16_f32 v45, v70, v71
    v_mfma_f32_32x32x16_bf16 v[84:99], v[32:35], v[48:51], v[84:99]
    v_exp_f32 v74, v74
    v_exp_f32 v75, v75
    v_cvt_pk_bf16_f32 v46, v72, v73
    v_exp_f32 v76, v76
    v_exp_f32 v77, v77
    v_cvt_pk_bf16_f32 v47, v74, v75
    v_exp_f32 v78, v78
    v_exp_f32 v79, v79
    v_mfma_f32_32x32x16_bf16 v[100:115], v[28:31], v[44:47], v[100:115]
    v_cvt_pk_bf16_f32 v48, v76, v77
    v_exp_f32 v80, v80
    v_exp_f32 v81, v81
    v_cvt_pk_bf16_f32 v49, v78, v79
    v_exp_f32 v82, v82
    v_exp_f32 v83, v83
    v_cvt_pk_bf16_f32 v50, v80, v81
    v_exp_f32 v52, v52
    v_exp_f32 v53, v53
    v_cvt_pk_bf16_f32 v51, v82, v83
    v_mfma_f32_32x32x16_bf16 v[68:83], v[24:27], v[16:19], 0
    v_exp_f32 v54, v54
    v_exp_f32 v55, v55
    v_cvt_pk_bf16_f32 v44, v52, v53
    v_exp_f32 v56, v56
    v_exp_f32 v57, v57
    v_cvt_pk_bf16_f32 v45, v54, v55
    v_mfma_f32_32x32x16_bf16 v[100:115], v[32:35], v[48:51], v[100:115]
    ds_read_b128 v[20:23], v2 offset:6144
    s_mov_b64 exec, s[12:13]
    ds_read_b128 v[28:31], v3 offset:6144
    ds_read_b128 v[32:35], v3 offset:6656
    s_mov_b64 exec, -1
    v_exp_f32 v58, v58
    v_exp_f32 v59, v59
    v_cvt_pk_bf16_f32 v46, v56, v57
    v_exp_f32 v60, v60
    v_exp_f32 v61, v61
    v_cvt_pk_bf16_f32 v47, v58, v59
    v_exp_f32 v62, v62
    v_exp_f32 v63, v63
    v_mfma_f32_32x32x16_bf16 v[84:99], v[36:39], v[44:47], v[84:99]
    v_cvt_pk_bf16_f32 v48, v60, v61
    v_exp_f32 v64, v64
    v_exp_f32 v65, v65
    v_cvt_pk_bf16_f32 v49, v62, v63
    v_exp_f32 v66, v66
    v_exp_f32 v67, v67
    v_cvt_pk_bf16_f32 v50, v64, v65
    v_exp_f32 v68, v68
    v_exp_f32 v69, v69
    v_cvt_pk_bf16_f32 v51, v66, v67
    s_waitcnt lgkmcnt(0)
    v_mfma_f32_32x32x16_bf16 v[52:67], v[20:23], v[12:15], 0
    v_exp_f32 v70, v70
    v_exp_f32 v71, v71
    v_cvt_pk_bf16_f32 v44, v68, v69
    v_exp_f32 v72, v72
    v_exp_f32 v73, v73
    v_cvt_pk_bf16_f32 v45, v70, v71
    v_mfma_f32_32x32x16_bf16 v[84:99], v[40:43], v[48:51], v[84:99]
    v_exp_f32 v74, v74
    v_exp_f32 v75, v75
    v_cvt_pk_bf16_f32 v46, v72, v73
    v_exp_f32 v76, v76
    v_exp_f32 v77, v77
    v_cvt_pk_bf16_f32 v47, v74, v75
    v_exp_f32 v78, v78
    v_exp_f32 v79, v79
    v_mfma_f32_32x32x16_bf16 v[100:115], v[36:39], v[44:47], v[100:115]
    v_cvt_pk_bf16_f32 v48, v76, v77
    v_exp_f32 v80, v80
    v_exp_f32 v81, v81
    v_cvt_pk_bf16_f32 v49, v78, v79
    v_exp_f32 v82, v82
    v_exp_f32 v83, v83
    v_cvt_pk_bf16_f32 v50, v80, v81
    v_exp_f32 v52, v52
    v_exp_f32 v53, v53
    v_cvt_pk_bf16_f32 v51, v82, v83
    v_mfma_f32_32x32x16_bf16 v[68:83], v[20:23], v[16:19], 0
    v_exp_f32 v54, v54
    v_exp_f32 v55, v55
    v_cvt_pk_bf16_f32 v44, v52, v53
    v_exp_f32 v56, v56
    v_exp_f32 v57, v57
    v_cvt_pk_bf16_f32 v45, v54, v55
    v_mfma_f32_32x32x16_bf16 v[100:115], v[40:43], v[48:51], v[100:115]
    ds_read_b128 v[24:27], v2 offset:7168
    s_mov_b64 exec, s[12:13]
    ds_read_b128 v[36:39], v3 offset:7168
    ds_read_b128 v[40:43], v3 offset:7680
    s_mov_b64 exec, -1
    v_exp_f32 v58, v58
    v_exp_f32 v59, v59
    v_cvt_pk_bf16_f32 v46, v56, v57
    v_exp_f32 v60, v60
    v_exp_f32 v61, v61
    v_cvt_pk_bf16_f32 v47, v58, v59
    v_exp_f32 v62, v62
    v_exp_f32 v63, v63
    v_mfma_f32_32x32x16_bf16 v[84:99], v[28:31], v[44:47], v[84:99]
    v_cvt_pk_bf16_f32 v48, v60, v61
    v_exp_f32 v64, v64
    v_exp_f32 v65, v65
    v_cvt_pk_bf16_f32 v49, v62, v63
    v_exp_f32 v66, v66
    v_exp_f32 v67, v67
    v_cvt_pk_bf16_f32 v50, v64, v65
    v_exp_f32 v68, v68
    v_exp_f32 v69, v69
    v_cvt_pk_bf16_f32 v51, v66, v67
    s_waitcnt lgkmcnt(0)
    v_mfma_f32_32x32x16_bf16 v[52:67], v[24:27], v[12:15], 0
    v_exp_f32 v70, v70
    v_exp_f32 v71, v71
    v_cvt_pk_bf16_f32 v44, v68, v69
    v_exp_f32 v72, v72
    v_exp_f32 v73, v73
    v_cvt_pk_bf16_f32 v45, v70, v71
    v_mfma_f32_32x32x16_bf16 v[84:99], v[32:35], v[48:51], v[84:99]
    v_exp_f32 v74, v74
    v_exp_f32 v75, v75
    v_cvt_pk_bf16_f32 v46, v72, v73
    v_exp_f32 v76, v76
    v_exp_f32 v77, v77
    v_cvt_pk_bf16_f32 v47, v74, v75
    v_exp_f32 v78, v78
    v_exp_f32 v79, v79
    v_mfma_f32_32x32x16_bf16 v[100:115], v[28:31], v[44:47], v[100:115]
    v_cvt_pk_bf16_f32 v48, v76, v77
    v_exp_f32 v80, v80
    v_exp_f32 v81, v81
    v_cvt_pk_bf16_f32 v49, v78, v79
    v_exp_f32 v82, v82
    v_exp_f32 v83, v83
    v_cvt_pk_bf16_f32 v50, v80, v81
    v_exp_f32 v52, v52
    v_exp_f32 v53, v53
    v_cvt_pk_bf16_f32 v51, v82, v83
    v_mfma_f32_32x32x16_bf16 v[68:83], v[24:27], v[16:19], 0
    v_exp_f32 v54, v54
    v_exp_f32 v55, v55
    v_cvt_pk_bf16_f32 v44, v52, v53
    v_exp_f32 v56, v56
    v_exp_f32 v57, v57
    v_cvt_pk_bf16_f32 v45, v54, v55
    v_mfma_f32_32x32x16_bf16 v[100:115], v[32:35], v[48:51], v[100:115]
    s_bitcmp1_b32 s15, s14
    s_cbranch_scc0 L_k2_nobar7
    s_barrier
L_k2_nobar7:
    ds_read_b128 v[20:23], v2 offset:8192
    s_mov_b64 exec, s[12:13]
    ds_read_b128 v[28:31], v3 offset:8192
    ds_read_b128 v[32:35], v3 offset:8704
    s_mov_b64 exec, -1
    v_exp_f32 v58, v58
    v_exp_f32 v59, v59
    v_cvt_pk_bf16_f32 v46, v56, v57
    v_exp_f32 v60, v60
    v_exp_f32 v61, v61
    v_cvt_pk_bf16_f32 v47, v58, v59
    v_exp_f32 v62, v62
    v_exp_f32 v63, v63
    v_mfma_f32_32x32x16_bf16 v[84:99], v[36:39], v[44:47], v[84:99]
    v_cvt_pk_bf16_f32 v48, v60, v61
    v_exp_f32 v64, v64
    v_exp_f32 v65, v65
    v_cvt_pk_bf16_f32 v49, v62, v63
    v_exp_f32 v66, v66
    v_exp_f32 v67, v67
    v_cvt_pk_bf16_f32 v50, v64, v65
    v_add_u32 v2, 8192, v2
    v_add_u32 v3, 8192, v3
    v_exp_f32 v68, v68
    v_exp_f32 v69, v69
    v_cvt_pk_bf16_f32 v51, v66, v67
    s_waitcnt lgkmcnt(0)
    v_mfma_f32_32x32x16_bf16 v[52:67], v[20:23], v[12:15], 0
    v_exp_f32 v70, v70
    v_exp_f32 v71, v71
    v_cvt_pk_bf16_f32 v44, v68, v69
    v_exp_f32 v72, v72
    v_exp_f32 v73, v73
    v_cvt_pk_bf16_f32 v45, v70, v71
    v_mfma_f32_32x32x16_bf16 v[84:99], v[40:43], v[48:51], v[84:99]
    v_exp_f32 v74, v74
    v_exp_f32 v75, v75
    v_cvt_pk_bf16_f32 v46, v72, v73
    v_exp_f32 v76, v76
    v_exp_f32 v77, v77
    v_cvt_pk_bf16_f32 v47, v74, v75
    v_exp_f32 v78, v78
    v_exp_f32 v79, v79
    v_mfma_f32_32x32x16_bf16 v[100:115], v[36:39], v[44:47], v[100:115]
    v_cvt_pk_bf16_f32 v48, v76, v77
    v_exp_f32 v80, v80
    v_exp_f32 v81, v81
    v_cvt_pk_bf16_f32 v49, v78, v79
    v_exp_f32 v82, v82
    v_exp_f32 v83, v83
    v_cvt_pk_bf16_f32 v50, v80, v81
    s_add_u32 s14, s14, 1
    s_cmp_lt_u32 s14, 8
    s_cbranch_scc1 L_k2_loop
    v_cvt_pk_bf16_f32 v51, v82, v83
    s_nop 1
    v_mfma_f32_32x32x16_bf16 v[100:115], v[40:43], v[48:51], v[100:115]
    s_waitcnt lgkmcnt(0)
    s_nop 7
    s_nop 7
    s_mov_b32 s24, 0x30800000
    s_mov_b32 s25, 0x5d800000
    v_mul_f32 v5, 0, v92
    v_fma_f32 v5, v84, 0, v5
    v_fma_f32 v5, v85, 0, v5
    v_fma_f32 v5, v86, 0, v5
    v_fma_f32 v5, v87, 0, v5
    v_fma_f32 v5, v88, 0, v5
    v_fma_f32 v5, v89, 0, v5
    v_fma_f32 v5, v90, 0, v5
    v_fma_f32 v5, v91, 0, v5
    v_fma_f32 v5, v108, 0, v5
    v_fma_f32 v5, v100, 0, v5
    v_fma_f32 v5, v101, 0, v5
    v_fma_f32 v5, v102, 0, v5
    v_fma_f32 v5, v103, 0, v5
    v_fma_f32 v5, v104, 0, v5
    v_fma_f32 v5, v105, 0, v5
    v_fma_f32 v5, v106, 0, v5
    v_fma_f32 v5, v107, 0, v5
    v_cmp_u_f32 vcc, v5, v5
    v_min_f32 v6, v92, v108
    v_max_f32 v7, v92, v108
    v_cmp_gt_f32 s[26:27], s24, v6
    v_cmp_lt_f32 s[28:29], s25, v7
    s_nop 3
    s_or_b64 vcc, vcc, s[26:27]
    s_or_b64 vcc, vcc, s[28:29]
    s_cbranch_vccz L_k2_norm
    v_mov_b32 v4, 0xff800000
    v_lshlrev_b32 v2, 4, v1
    s_mov_b32 s14, 0
L_k2_fb1_a:
    ds_read_b128 v[20:23], v2
    v_add_u32 v2, 1024, v2
    s_waitcnt lgkmcnt(0)
    v_mfma_f32_32x32x16_bf16 v[52:67], v[20:23], v[12:15], 0
    s_nop 7
    s_nop 7
    v_max3_f32 v4, v52, v53, v4
    v_max3_f32 v4, v54, v55, v4
    v_max3_f32 v4, v56, v57, v4
    v_max3_f32 v4, v58, v59, v4
    v_max3_f32 v4, v60, v61, v4
    v_max3_f32 v4, v62, v63, v4
    v_max3_f32 v4, v64, v65, v4
    v_max3_f32 v4, v66, v67, v4
    s_add_u32 s14, s14, 1
    s_cmp_lt_u32 s14, 64
    s_cbranch_scc1 L_k2_fb1_a
    v_mov_b32 v5, v4
    s_nop 1
    v_permlane32_swap_b32 v4, v5
    s_nop 1
    v_max_f32 v4, v4, v5
    v_sub_f32 v116, 0, v4
    v_mov_b32 v84, 0
    v_sub_f32 v117, 0, v4
    v_mov_b32 v85, 0
    v_sub_f32 v118, 0, v4
    v_mov_b32 v86, 0
    v_sub_f32 v119, 0, v4
    v_mov_b32 v87, 0
    v_sub_f32 v120, 0, v4
    v_mov_b32 v88, 0
    v_sub_f32 v121, 0, v4
    v_mov_b32 v89, 0
    v_sub_f32 v122, 0, v4
    v_mov_b32 v90, 0
    v_sub_f32 v123, 0, v4
    v_mov_b32 v91, 0
    v_sub_f32 v124, 0, v4
    v_mov_b32 v92, 0
    v_sub_f32 v125, 0, v4
    v_mov_b32 v93, 0
    v_sub_f32 v126, 0, v4
    v_mov_b32 v94, 0
    v_sub_f32 v127, 0, v4
    v_mov_b32 v95, 0
    v_sub_f32 v128, 0, v4
    v_mov_b32 v96, 0
    v_sub_f32 v129, 0, v4
    v_mov_b32 v97, 0
    v_sub_f32 v130, 0, v4
    v_mov_b32 v98, 0
    v_sub_f32 v131, 0, v4
    v_mov_b32 v99, 0
    v_lshlrev_b32 v2, 4, v1
    v_and_b32 v3, 15, v1
    v_lshrrev_b32 v5, 5, v1
    v_lshl_add_u32 v3, v5, 4, v3
    v_lshlrev_b32 v3, 4, v3
    v_add_u32 v3, 0x10000, v3
    s_mov_b32 s14, 0
L_k2_fb2_a:
    ds_read_b128 v[20:23], v2
    s_mov_b64 exec, s[12:13]
    ds_read_b128 v[28:31], v3
    ds_read_b128 v[32:35], v3 offset:512
    s_mov_b64 exec, -1
    v_add_u32 v2, 1024, v2
    v_add_u32 v3, 1024, v3
    s_waitcnt lgkmcnt(0)
    v_mfma_f32_32x32x16_bf16 v[52:67], v[20:23], v[12:15], v[116:131]
    s_nop 7
    s_nop 7
    v_exp_f32 v52, v52
    v_exp_f32 v53, v53
    v_exp_f32 v54, v54
    v_exp_f32 v55, v55
    v_exp_f32 v56, v56
    v_exp_f32 v57, v57
    v_exp_f32 v58, v58
    v_exp_f32 v59, v59
    v_exp_f32 v60, v60
    v_exp_f32 v61, v61
    v_exp_f32 v62, v62
    v_exp_f32 v63, v63
    v_exp_f32 v64, v64
    v_exp_f32 v65, v65
    v_exp_f32 v66, v66
    v_exp_f32 v67, v67
    s_nop 0
    v_cvt_pk_bf16_f32 v44, v52, v53
    v_cvt_pk_bf16_f32 v45, v54, v55
    v_cvt_pk_bf16_f32 v46, v56, v57
    v_cvt_pk_bf16_f32 v47, v58, v59
    v_cvt_pk_bf16_f32 v48, v60, v61
    v_cvt_pk_bf16_f32 v49, v62, v63
    v_cvt_pk_bf16_f32 v50, v64, v65
    v_cvt_pk_bf16_f32 v51, v66, v67
    s_nop 1
    v_mfma_f32_32x32x16_bf16 v[84:99], v[28:31], v[44:47], v[84:99]
    v_mfma_f32_32x32x16_bf16 v[84:99], v[32:35], v[48:51], v[84:99]
    s_add_u32 s14, s14, 1
    s_cmp_lt_u32 s14, 64
    s_cbranch_scc1 L_k2_fb2_a
    s_nop 7
    s_nop 7
    v_mov_b32 v4, 0xff800000
    v_lshlrev_b32 v2, 4, v1
    s_mov_b32 s14, 0
L_k2_fb1_b:
    ds_read_b128 v[20:23], v2
    v_add_u32 v2, 1024, v2
    s_waitcnt lgkmcnt(0)
    v_mfma_f32_32x32x16_bf16 v[52:67], v[20:23], v[16:19], 0
    s_nop 7
    s_nop 7
    v_max3_f32 v4, v52, v53, v4
    v_max3_f32 v4, v54, v55, v4
    v_max3_f32 v4, v56, v57, v4
    v_max3_f32 v4, v58, v59, v4
    v_max3_f32 v4, v60, v61, v4
    v_max3_f32 v4, v62, v63, v4
    v_max3_f32 v4, v64, v65, v4
    v_max3_f32 v4, v66, v67, v4
    s_add_u32 s14, s14, 1
    s_cmp_lt_u32 s14, 64
    s_cbranch_scc1 L_k2_fb1_b
    v_mov_b32 v5, v4
    s_nop 1
    v_permlane32_swap_b32 v4, v5
    s_nop 1
    v_max_f32 v4, v4, v5
    v_sub_f32 v116, 0, v4
    v_mov_b32 v100, 0
    v_sub_f32 v117, 0, v4
    v_mov_b32 v101, 0
    v_sub_f32 v118, 0, v4
    v_mov_b32 v102, 0
    v_sub_f32 v119, 0, v4
    v_mov_b32 v103, 0
    v_sub_f32 v120, 0, v4
    v_mov_b32 v104, 0
    v_sub_f32 v121, 0, v4
    v_mov_b32 v105, 0
    v_sub_f32 v122, 0, v4
    v_mov_b32 v106, 0
    v_sub_f32 v123, 0, v4
    v_mov_b32 v107, 0
    v_sub_f32 v124, 0, v4
    v_mov_b32 v108, 0
    v_sub_f32 v125, 0, v4
    v_mov_b32 v109, 0
    v_sub_f32 v126, 0, v4
    v_mov_b32 v110, 0
    v_sub_f32 v127, 0, v4
    v_mov_b32 v111, 0
    v_sub_f32 v128, 0, v4
    v_mov_b32 v112, 0
    v_sub_f32 v129, 0, v4
    v_mov_b32 v113, 0
    v_sub_f32 v130, 0, v4
    v_mov_b32 v114, 0
    v_sub_f32 v131, 0, v4
    v_mov_b32 v115, 0
    v_lshlrev_b32 v2, 4, v1
    v_and_b32 v3, 15, v1
    v_lshrrev_b32 v5, 5, v1
    v_lshl_add_u32 v3, v5, 4, v3
    v_lshlrev_b32 v3, 4, v3
    v_add_u32 v3, 0x10000, v3
    s_mov_b32 s14, 0
L_k2_fb2_b:
    ds_read_b128 v[20:23], v2
    s_mov_b64 exec, s[12:13]
    ds_read_b128 v[28:31], v3
    ds_read_b128 v[32:35], v3 offset:512
    s_mov_b64 exec, -1
    v_add_u32 v2, 1024, v2
    v_add_u32 v3, 1024, v3
    s_waitcnt lgkmcnt(0)
    v_mfma_f32_32x32x16_bf16 v[52:67], v[20:23], v[16:19], v[116:131]
    s_nop 7
    s_nop 7
    v_exp_f32 v52, v52
    v_exp_f32 v53, v53
    v_exp_f32 v54, v54
    v_exp_f32 v55, v55
    v_exp_f32 v56, v56
    v_exp_f32 v57, v57
    v_exp_f32 v58, v58
    v_exp_f32 v59, v59
    v_exp_f32 v60, v60
    v_exp_f32 v61, v61
    v_exp_f32 v62, v62
    v_exp_f32 v63, v63
    v_exp_f32 v64, v64
    v_exp_f32 v65, v65
    v_exp_f32 v66, v66
    v_exp_f32 v67, v67
    s_nop 0
    v_cvt_pk_bf16_f32 v44, v52, v53
    v_cvt_pk_bf16_f32 v45, v54, v55
    v_cvt_pk_bf16_f32 v46, v56, v57
    v_cvt_pk_bf16_f32 v47, v58, v59
    v_cvt_pk_bf16_f32 v48, v60, v61
    v_cvt_pk_bf16_f32 v49, v62, v63
    v_cvt_pk_bf16_f32 v50, v64, v65
    v_cvt_pk_bf16_f32 v51, v66, v67
    s_nop 1
    v_mfma_f32_32x32x16_bf16 v[100:115], v[28:31], v[44:47], v[100:115]
    v_mfma_f32_32x32x16_bf16 v[100:115], v[32:35], v[48:51], v[100:115]
    s_add_u32 s14, s14, 1
    s_cmp_lt_u32 s14, 64
    s_cbranch_scc1 L_k2_fb2_b
    s_nop 7
    s_nop 7
L_k2_norm:
    v_lshlrev_b32 v4, 4, v1
    v_rcp_f32 v5, v92
    s_nop 0
    v_mul_f32 v84, v84, v5
    v_mul_f32 v85, v85, v5
    v_mul_f32 v86, v86, v5
    v_mul_f32 v87, v87, v5
    v_mul_f32 v88, v88, v5
    v_mul_f32 v89, v89, v5
    v_mul_f32 v90, v90, v5
    v_mul_f32 v91, v91, v5
    v_cvt_pk_bf16_f32 v44, v84, v85
    v_cvt_pk_bf16_f32 v45, v86, v87
    v_cvt_pk_bf16_f32 v46, v88, v89
    v_cvt_pk_bf16_f32 v47, v90, v91
    v_rcp_f32 v5, v108
    s_nop 0
    v_mul_f32 v100, v100, v5
    v_mul_f32 v101, v101, v5
    v_mul_f32 v102, v102, v5
    v_mul_f32 v103, v103, v5
    v_mul_f32 v104, v104, v5
    v_mul_f32 v105, v105, v5
    v_mul_f32 v106, v106, v5
    v_mul_f32 v107, v107, v5
    v_cvt_pk_bf16_f32 v48, v100, v101
    v_cvt_pk_bf16_f32 v49, v102, v103
    v_cvt_pk_bf16_f32 v50, v104, v105
    v_cvt_pk_bf16_f32 v51, v106, v107
    v_min_u32 v44, -2, v44
    v_min_u32 v45, -2, v45
    v_min_u32 v46, -2, v46
    v_min_u32 v47, -2, v47
    v_min_u32 v48, -2, v48
    v_min_u32 v49, -2, v49
    v_min_u32 v50, -2, v50
    v_min_u32 v51, -2, v51
    s_add_u32 s17, s17, 2097152
    s_add_u32 s16, s16, 2097152
    buffer_store_dwordx4 v[44:47], v4, s[4:7], s17 offen sc1
    buffer_store_dwordx4 v[48:51], v4, s[4:7], s16 offen sc1
    s_waitcnt vmcnt(0)
    s_barrier
    s_barrier
    s_endpgm
L_k2_ffn:
    s_lshl_b32 s20, s8, 10
    s_add_u32 s21, s20, 15990784
    s_mov_b32 m0, s20
    s_add_u32 s22, s21, 0
    buffer_load_dwordx4 v4, s[4:7], s22 offen lds
    s_add_u32 m0, s20, 65536
    s_add_u32 s22, s21, 65536
    buffer_load_dwordx4 v4, s[4:7], s22 offen lds
    s_waitcnt vmcnt(0)
    s_barrier
    s_sub_u32 s20, s8, 4
    s_lshl_b32 s20, s20, 11
    s_add_u32 s21, s20, 15990784
    s_add_u32 m0, s20, 8192
    s_add_u32 s22, s21, 8192
    buffer_load_dwordx4 v4, s[4:7], s22 offen lds
    s_add_u32 m0, s20, 9216
    s_add_u32 s22, s21, 9216
    buffer_load_dwordx4 v4, s[4:7], s22 offen lds
    s_add_u32 m0, s20, 73728
    s_add_u32 s22, s21, 73728
    buffer_load_dwordx4 v4, s[4:7], s22 offen lds
    s_add_u32 m0, s20, 74752
    s_add_u32 s22, s21, 74752
    buffer_load_dwordx4 v4, s[4:7], s22 offen lds
    s_add_u32 m0, s20, 16384
    s_add_u32 s22, s21, 16384
    buffer_load_dwordx4 v4, s[4:7], s22 offen lds
    s_add_u32 m0, s20, 17408
    s_add_u32 s22, s21, 17408
    buffer_load_dwordx4 v4, s[4:7], s22 offen lds
    s_add_u32 m0, s20, 81920
    s_add_u32 s22, s21, 81920
    buffer_load_dwordx4 v4, s[4:7], s22 offen lds
    s_add_u32 m0, s20, 82944
    s_add_u32 s22, s21, 82944
    buffer_load_dwordx4 v4, s[4:7], s22 offen lds
    s_add_u32 m0, s20, 24576
    s_add_u32 s22, s21, 24576
    buffer_load_dwordx4 v4, s[4:7], s22 offen lds
    s_add_u32 m0, s20, 25600
    s_add_u32 s22, s21, 25600
    buffer_load_dwordx4 v4, s[4:7], s22 offen lds
    s_add_u32 m0, s20, 90112
    s_add_u32 s22, s21, 90112
    buffer_load_dwordx4 v4, s[4:7], s22 offen lds
    s_add_u32 m0, s20, 91136
    s_add_u32 s22, s21, 91136
    buffer_load_dwordx4 v4, s[4:7], s22 offen lds
    s_add_u32 m0, s20, 32768
    s_add_u32 s22, s21, 32768
    buffer_load_dwordx4 v4, s[4:7], s22 offen lds
    s_add_u32 m0, s20, 33792
    s_add_u32 s22, s21, 33792
    buffer_load_dwordx4 v4, s[4:7], s22 offen lds
    s_add_u32 m0, s20, 98304
    s_add_u32 s22, s21, 98304
    buffer_load_dwordx4 v4, s[4:7], s22 offen lds
    s_add_u32 m0, s20, 99328
    s_add_u32 s22, s21, 99328
    buffer_load_dwordx4 v4, s[4:7], s22 offen lds
    s_add_u32 m0, s20, 40960
    s_add_u32 s22, s21, 40960
    buffer_load_dwordx4 v4, s[4:7], s22 offen lds
    s_add_u32 m0, s20, 41984
    s_add_u32 s22, s21, 41984
    buffer_load_dwordx4 v4, s[4:7], s22 offen lds
    s_add_u32 m0, s20, 106496
    s_add_u32 s22, s21, 106496
    buffer_load_dwordx4 v4, s[4:7], s22 offen lds
    s_add_u32 m0, s20, 107520
    s_add_u32 s22, s21, 107520
    buffer_load_dwordx4 v4, s[4:7], s22 offen lds
    s_add_u32 m0, s20, 49152
    s_add_u32 s22, s21, 49152
    buffer_load_dwordx4 v4, s[4:7], s22 offen lds
    s_add_u32 m0, s20, 50176
    s_add_u32 s22, s21, 50176
    buffer_load_dwordx4 v4, s[4:7], s22 offen lds
    s_add_u32 m0, s20, 114688
    s_add_u32 s22, s21, 114688
    buffer_load_dwordx4 v4, s[4:7], s22 offen lds
    s_add_u32 m0, s20, 115712
    s_add_u32 s22, s21, 115712
    buffer_load_dwordx4 v4, s[4:7], s22 offen lds
    s_add_u32 m0, s20, 57344
    s_add_u32 s22, s21, 57344
    buffer_load_dwordx4 v4, s[4:7], s22 offen lds
    s_add_u32 m0, s20, 58368
    s_add_u32 s22, s21, 58368
    buffer_load_dwordx4 v4, s[4:7], s22 offen lds
    s_add_u32 m0, s20, 122880
    s_add_u32 s22, s21, 122880
    buffer_load_dwordx4 v4, s[4:7], s22 offen lds
    s_add_u32 m0, s20, 123904
    s_add_u32 s22, s21, 123904
    buffer_load_dwordx4 v4, s[4:7], s22 offen lds
    s_sub_u32 s11, s8, 4
    s_mul_i32 s16, s11, 28672
    s_mul_i32 s20, s9, 229376
    s_add_u32 s20, s20, s16
    s_add_u32 s20, s20, 6291456
    s_add_u32 s21, s20, 114688
    s_mul_i32 s22, s10, 229376
    s_add_u32 s22, s22, s16
    s_add_u32 s22, s22, 13631488
    s_add_u32 s23, s22, 114688
    buffer_load_dwordx4 v[76:79], v4, s[4:7], s22 offen offset:0
    buffer_load_dwordx4 v[80:83], v4, s[4:7], s23 offen offset:0
    buffer_load_dwordx4 v[84:87], v4, s[4:7], s20 offen offset:0
    buffer_load_dwordx4 v[88:91], v4, s[4:7], s21 offen offset:0
    buffer_load_dwordx4 v[92:95], v4, s[4:7], s22 offen offset:1024
    buffer_load_dwordx4 v[96:99], v4, s[4:7], s23 offen offset:1024
    buffer_load_dwordx4 v[100:103], v4, s[4:7], s20 offen offset:1024
    buffer_load_dwordx4 v[104:107], v4, s[4:7], s21 offen offset:1024
    s_waitcnt vmcnt(8)
    s_barrier
    buffer_load_dwordx4 v[108:111], v4, s[4:7], s22 offen offset:2048
    buffer_load_dwordx4 v[112:115], v4, s[4:7], s23 offen offset:2048
    buffer_load_dwordx4 v[116:119], v4, s[4:7], s20 offen offset:2048
    buffer_load_dwordx4 v[120:123], v4, s[4:7], s21 offen offset:2048
    buffer_load_dwordx4 v[124:127], v4, s[4:7], s22 offen offset:3072
    buffer_load_dwordx4 v[128:131], v4, s[4:7], s23 offen offset:3072
    buffer_load_dwordx4 v[132:135], v4, s[4:7], s20 offen offset:3072
    buffer_load_dwordx4 v[136:139], v4, s[4:7], s21 offen offset:3072
    s_add_u32 s20, s20, 4096
    s_add_u32 s21, s21, 4096
    s_add_u32 s22, s22, 4096
    s_add_u32 s23, s23, 4096
    buffer_load_dwordx4 v[140:143], v4, s[4:7], s22 offen offset:0
    buffer_load_dwordx4 v[144:147], v4, s[4:7], s23 offen offset:0
    buffer_load_dwordx4 v[148:151], v4, s[4:7], s20 offen offset:0
    buffer_load_dwordx4 v[152:155], v4, s[4:7], s21 offen offset:0
    buffer_load_dwordx4 v[156:159], v4, s[4:7], s22 offen offset:1024
    buffer_load_dwordx4 v[160:163], v4, s[4:7], s23 offen offset:1024
    buffer_load_dwordx4 v[164:167], v4, s[4:7], s20 offen offset:1024
    buffer_load_dwordx4 v[168:171], v4, s[4:7], s21 offen offset:1024
    buffer_load_dwordx4 v[172:175], v4, s[4:7], s22 offen offset:2048
    buffer_load_dwordx4 v[176:179], v4, s[4:7], s23 offen offset:2048
    buffer_load_dwordx4 v[180:183], v4, s[4:7], s20 offen offset:2048
    buffer_load_dwordx4 v[184:187], v4, s[4:7], s21 offen offset:2048
    buffer_load_dwordx4 v[188:191], v4, s[4:7], s22 offen offset:3072
    buffer_load_dwordx4 v[192:195], v4, s[4:7], s23 offen offset:3072
    buffer_load_dwordx4 v[196:199], v4, s[4:7], s20 offen offset:3072
    buffer_load_dwordx4 v[200:203], v4, s[4:7], s21 offen offset:3072
    s_waitcnt vmcnt(28)
    v_mfma_f32_32x32x16_bf16 v[12:27], v[76:79], v[84:87], 0
    v_mfma_f32_32x32x16_bf16 v[28:43], v[76:79], v[88:91], 0
    v_mfma_f32_32x32x16_bf16 v[44:59], v[80:83], v[84:87], 0
    v_mfma_f32_32x32x16_bf16 v[60:75], v[80:83], v[88:91], 0
    s_add_u32 s20, s20, 4096
    s_add_u32 s21, s21, 4096
    s_add_u32 s22, s22, 4096
    s_add_u32 s23, s23, 4096
    buffer_load_dwordx4 v[76:79], v4, s[4:7], s22 offen offset:0
    buffer_load_dwordx4 v[80:83], v4, s[4:7], s23 offen offset:0
    buffer_load_dwordx4 v[84:87], v4, s[4:7], s20 offen offset:0
    buffer_load_dwordx4 v[88:91], v4, s[4:7], s21 offen offset:0
    s_waitcnt vmcnt(28)
    v_mfma_f32_32x32x16_bf16 v[12:27], v[92:95], v[100:103], v[12:27]
    v_mfma_f32_32x32x16_bf16 v[28:43], v[92:95], v[104:107], v[28:43]
    v_mfma_f32_32x32x16_bf16 v[44:59], v[96:99], v[100:103], v[44:59]
    v_mfma_f32_32x32x16_bf16 v[60:75], v[96:99], v[104:107], v[60:75]
    buffer_load_dwordx4 v[92:95], v4, s[4:7], s22 offen offset:1024
    buffer_load_dwordx4 v[96:99], v4, s[4:7], s23 offen offset:1024
    buffer_load_dwordx4 v[100:103], v4, s[4:7], s20 offen offset:1024
    buffer_load_dwordx4 v[104:107], v4, s[4:7], s21 offen offset:1024
    s_waitcnt vmcnt(28)
    v_mfma_f32_32x32x16_bf16 v[12:27], v[108:111], v[116:119], v[12:27]
    v_mfma_f32_32x32x16_bf16 v[28:43], v[108:111], v[120:123], v[28:43]
    v_mfma_f32_32x32x16_bf16 v[44:59], v[112:115], v[116:119], v[44:59]
    v_mfma_f32_32x32x16_bf16 v[60:75], v[112:115], v[120:123], v[60:75]
    buffer_load_dwordx4 v[108:111], v4, s[4:7], s22 offen offset:2048
    buffer_load_dwordx4 v[112:115], v4, s[4:7], s23 offen offset:2048
    buffer_load_dwordx4 v[116:119], v4, s[4:7], s20 offen offset:2048
    buffer_load_dwordx4 v[120:123], v4, s[4:7], s21 offen offset:2048
    s_waitcnt vmcnt(28)
    v_mfma_f32_32x32x16_bf16 v[12:27], v[124:127], v[132:135], v[12:27]
    v_mfma_f32_32x32x16_bf16 v[28:43], v[124:127], v[136:139], v[28:43]
    v_mfma_f32_32x32x16_bf16 v[44:59], v[128:131], v[132:135], v[44:59]
    v_mfma_f32_32x32x16_bf16 v[60:75], v[128:131], v[136:139], v[60:75]
    buffer_load_dwordx4 v[124:127], v4, s[4:7], s22 offen offset:3072
    buffer_load_dwordx4 v[128:131], v4, s[4:7], s23 offen offset:3072
    buffer_load_dwordx4 v[132:135], v4, s[4:7], s20 offen offset:3072
    buffer_load_dwordx4 v[136:139], v4, s[4:7], s21 offen offset:3072
    s_waitcnt vmcnt(28)
    v_mfma_f32_32x32x16_bf16 v[12:27], v[140:143], v[148:151], v[12:27]
    v_mfma_f32_32x32x16_bf16 v[28:43], v[140:143], v[152:155], v[28:43]
    v_mfma_f32_32x32x16_bf16 v[44:59], v[144:147], v[148:151], v[44:59]
    v_mfma_f32_32x32x16_bf16 v[60:75], v[144:147], v[152:155], v[60:75]
    s_add_u32 s20, s20, 4096
    s_add_u32 s21, s21, 4096
    s_add_u32 s22, s22, 4096
    s_add_u32 s23, s23, 4096
    buffer_load_dwordx4 v[140:143], v4, s[4:7], s22 offen offset:0
    buffer_load_dwordx4 v[144:147], v4, s[4:7], s23 offen offset:0
    buffer_load_dwordx4 v[148:151], v4, s[4:7], s20 offen offset:0
    buffer_load_dwordx4 v[152:155], v4, s[4:7], s21 offen offset:0
    s_waitcnt vmcnt(28)
    v_mfma_f32_32x32x16_bf16 v[12:27], v[156:159], v[164:167], v[12:27]
    v_mfma_f32_32x32x16_bf16 v[28:43], v[156:159], v[168:171], v[28:43]
    v_mfma_f32_32x32x16_bf16 v[44:59], v[160:163], v[164:167], v[44:59]
    v_mfma_f32_32x32x16_bf16 v[60:75], v[160:163], v[168:171], v[60:75]
    buffer_load_dwordx4 v[156:159], v4, s[4:7], s22 offen offset:1024
    buffer_load_dwordx4 v[160:163], v4, s[4:7], s23 offen offset:1024
    buffer_load_dwordx4 v[164:167], v4, s[4:7], s20 offen offset:1024
    buffer_load_dwordx4 v[168:171], v4, s[4:7], s21 offen offset:1024
    s_waitcnt vmcnt(28)
    v_mfma_f32_32x32x16_bf16 v[12:27], v[172:175], v[180:183], v[12:27]
    v_mfma_f32_32x32x16_bf16 v[28:43], v[172:175], v[184:187], v[28:43]
    v_mfma_f32_32x32x16_bf16 v[44:59], v[176:179], v[180:183], v[44:59]
    v_mfma_f32_32x32x16_bf16 v[60:75], v[176:179], v[184:187], v[60:75]
    buffer_load_dwordx4 v[172:175], v4, s[4:7], s22 offen offset:2048
    buffer_load_dwordx4 v[176:179], v4, s[4:7], s23 offen offset:2048
    buffer_load_dwordx4 v[180:183], v4, s[4:7], s20 offen offset:2048
    buffer_load_dwordx4 v[184:187], v4, s[4:7], s21 offen offset:2048
    s_waitcnt vmcnt(28)
    v_mfma_f32_32x32x16_bf16 v[12:27], v[188:191], v[196:199], v[12:27]
    v_mfma_f32_32x32x16_bf16 v[28:43], v[188:191], v[200:203], v[28:43]
    v_mfma_f32_32x32x16_bf16 v[44:59], v[192:195], v[196:199], v[44:59]
    v_mfma_f32_32x32x16_bf16 v[60:75], v[192:195], v[200:203], v[60:75]
    buffer_load_dwordx4 v[188:191], v4, s[4:7], s22 offen offset:3072
    buffer_load_dwordx4 v[192:195], v4, s[4:7], s23 offen offset:3072
    buffer_load_dwordx4 v[196:199], v4, s[4:7], s20 offen offset:3072
    buffer_load_dwordx4 v[200:203], v4, s[4:7], s21 offen offset:3072
    s_waitcnt vmcnt(28)
    v_mfma_f32_32x32x16_bf16 v[12:27], v[76:79], v[84:87], v[12:27]
    v_mfma_f32_32x32x16_bf16 v[28:43], v[76:79], v[88:91], v[28:43]
    v_mfma_f32_32x32x16_bf16 v[44:59], v[80:83], v[84:87], v[44:59]
    v_mfma_f32_32x32x16_bf16 v[60:75], v[80:83], v[88:91], v[60:75]
    s_add_u32 s20, s20, 4096
    s_add_u32 s21, s21, 4096
    s_add_u32 s22, s22, 4096
    s_add_u32 s23, s23, 4096
    buffer_load_dwordx4 v[76:79], v4, s[4:7], s22 offen offset:0
    buffer_load_dwordx4 v[80:83], v4, s[4:7], s23 offen offset:0
    buffer_load_dwordx4 v[84:87], v4, s[4:7], s20 offen offset:0
    buffer_load_dwordx4 v[88:91], v4, s[4:7], s21 offen offset:0
    s_waitcnt vmcnt(28)
    v_mfma_f32_32x32x16_bf16 v[12:27], v[92:95], v[100:103], v[12:27]
    v_mfma_f32_32x32x16_bf16 v[28:43], v[92:95], v[104:107], v[28:43]
    v_mfma_f32_32x32x16_bf16 v[44:59], v[96:99], v[100:103], v[44:59]
    v_mfma_f32_32x32x16_bf16 v[60:75], v[96:99], v[104:107], v[60:75]
    buffer_load_dwordx4 v[92:95], v4, s[4:7], s22 offen offset:1024
    buffer_load_dwordx4 v[96:99], v4, s[4:7], s23 offen offset:1024
    buffer_load_dwordx4 v[100:103], v4, s[4:7], s20 offen offset:1024
    buffer_load_dwordx4 v[104:107], v4, s[4:7], s21 offen offset:1024
    s_waitcnt vmcnt(28)
    v_mfma_f32_32x32x16_bf16 v[12:27], v[108:111], v[116:119], v[12:27]
    v_mfma_f32_32x32x16_bf16 v[28:43], v[108:111], v[120:123], v[28:43]
    v_mfma_f32_32x32x16_bf16 v[44:59], v[112:115], v[116:119], v[44:59]
    v_mfma_f32_32x32x16_bf16 v[60:75], v[112:115], v[120:123], v[60:75]
    buffer_load_dwordx4 v[108:111], v4, s[4:7], s22 offen offset:2048
    buffer_load_dwordx4 v[112:115], v4, s[4:7], s23 offen offset:2048
    buffer_load_dwordx4 v[116:119], v4, s[4:7], s20 offen offset:2048
    buffer_load_dwordx4 v[120:123], v4, s[4:7], s21 offen offset:2048
    s_waitcnt vmcnt(28)
    v_mfma_f32_32x32x16_bf16 v[12:27], v[124:127], v[132:135], v[12:27]
    v_mfma_f32_32x32x16_bf16 v[28:43], v[124:127], v[136:139], v[28:43]
    v_mfma_f32_32x32x16_bf16 v[44:59], v[128:131], v[132:135], v[44:59]
    v_mfma_f32_32x32x16_bf16 v[60:75], v[128:131], v[136:139], v[60:75]
    buffer_load_dwordx4 v[124:127], v4, s[4:7], s22 offen offset:3072
    buffer_load_dwordx4 v[128:131], v4, s[4:7], s23 offen offset:3072
    buffer_load_dwordx4 v[132:135], v4, s[4:7], s20 offen offset:3072
    buffer_load_dwordx4 v[136:139], v4, s[4:7], s21 offen offset:3072
    s_waitcnt vmcnt(28)
    v_mfma_f32_32x32x16_bf16 v[12:27], v[140:143], v[148:151], v[12:27]
    v_mfma_f32_32x32x16_bf16 v[28:43], v[140:143], v[152:155], v[28:43]
    v_mfma_f32_32x32x16_bf16 v[44:59], v[144:147], v[148:151], v[44:59]
    v_mfma_f32_32x32x16_bf16 v[60:75], v[144:147], v[152:155], v[60:75]
    s_add_u32 s20, s20, 4096
    s_add_u32 s21, s21, 4096
    s_add_u32 s22, s22, 4096
    s_add_u32 s23, s23, 4096
    buffer_load_dwordx4 v[140:143], v4, s[4:7], s22 offen offset:0
    buffer_load_dwordx4 v[144:147], v4, s[4:7], s23 offen offset:0
    buffer_load_dwordx4 v[148:151], v4, s[4:7], s20 offen offset:0
    buffer_load_dwordx4 v[152:155], v4, s[4:7], s21 offen offset:0
    s_waitcnt vmcnt(28)
    v_mfma_f32_32x32x16_bf16 v[12:27], v[156:159], v[164:167], v[12:27]
    v_mfma_f32_32x32x16_bf16 v[28:43], v[156:159], v[168:171], v[28:43]
    v_mfma_f32_32x32x16_bf16 v[44:59], v[160:163], v[164:167], v[44:59]
    v_mfma_f32_32x32x16_bf16 v[60:75], v[160:163], v[168:171], v[60:75]
    buffer_load_dwordx4 v[156:159], v4, s[4:7], s22 offen offset:1024
    buffer_load_dwordx4 v[160:163], v4, s[4:7], s23 offen offset:1024
    buffer_load_dwordx4 v[164:167], v4, s[4:7], s20 offen offset:1024
    buffer_load_dwordx4 v[168:171], v4, s[4:7], s21 offen offset:1024
    s_waitcnt vmcnt(28)
    v_mfma_f32_32x32x16_bf16 v[12:27], v[172:175], v[180:183], v[12:27]
    v_mfma_f32_32x32x16_bf16 v[28:43], v[172:175], v[184:187], v[28:43]
    v_mfma_f32_32x32x16_bf16 v[44:59], v[176:179], v[180:183], v[44:59]
    v_mfma_f32_32x32x16_bf16 v[60:75], v[176:179], v[184:187], v[60:75]
    buffer_load_dwordx4 v[172:175], v4, s[4:7], s22 offen offset:2048
    buffer_load_dwordx4 v[176:179], v4, s[4:7], s23 offen offset:2048
    buffer_load_dwordx4 v[180:183], v4, s[4:7], s20 offen offset:2048
    buffer_load_dwordx4 v[184:187], v4, s[4:7], s21 offen offset:2048
    s_waitcnt vmcnt(28)
    v_mfma_f32_32x32x16_bf16 v[12:27], v[188:191], v[196:199], v[12:27]
    v_mfma_f32_32x32x16_bf16 v[28:43], v[188:191], v[200:203], v[28:43]
    v_mfma_f32_32x32x16_bf16 v[44:59], v[192:195], v[196:199], v[44:59]
    v_mfma_f32_32x32x16_bf16 v[60:75], v[192:195], v[200:203], v[60:75]
    buffer_load_dwordx4 v[188:191], v4, s[4:7], s22 offen offset:3072
    buffer_load_dwordx4 v[192:195], v4, s[4:7], s23 offen offset:3072
    buffer_load_dwordx4 v[196:199], v4, s[4:7], s20 offen offset:3072
    buffer_load_dwordx4 v[200:203], v4, s[4:7], s21 offen offset:3072
    s_waitcnt vmcnt(28)
    v_mfma_f32_32x32x16_bf16 v[12:27], v[76:79], v[84:87], v[12:27]
    v_mfma_f32_32x32x16_bf16 v[28:43], v[76:79], v[88:91], v[28:43]
    v_mfma_f32_32x32x16_bf16 v[44:59], v[80:83], v[84:87], v[44:59]
    v_mfma_f32_32x32x16_bf16 v[60:75], v[80:83], v[88:91], v[60:75]
    s_add_u32 s20, s20, 4096
    s_add_u32 s21, s21, 4096
    s_add_u32 s22, s22, 4096
    s_add_u32 s23, s23, 4096
    buffer_load_dwordx4 v[76:79], v4, s[4:7], s22 offen offset:0
    buffer_load_dwordx4 v[80:83], v4, s[4:7], s23 offen offset:0
    buffer_load_dwordx4 v[84:87], v4, s[4:7], s20 offen offset:0
    buffer_load_dwordx4 v[88:91], v4, s[4:7], s21 offen offset:0
    s_waitcnt vmcnt(28)
    v_mfma_f32_32x32x16_bf16 v[12:27], v[92:95], v[100:103], v[12:27]
    v_mfma_f32_32x32x16_bf16 v[28:43], v[92:95], v[104:107], v[28:43]
    v_mfma_f32_32x32x16_bf16 v[44:59], v[96:99], v[100:103], v[44:59]
    v_mfma_f32_32x32x16_bf16 v[60:75], v[96:99], v[104:107], v[60:75]
    buffer_load_dwordx4 v[92:95], v4, s[4:7], s22 offen offset:1024
    buffer_load_dwordx4 v[96:99], v4, s[4:7], s23 offen offset:1024
    buffer_load_dwordx4 v[100:103], v4, s[4:7], s20 offen offset:1024
    buffer_load_dwordx4 v[104:107], v4, s[4:7], s21 offen offset:1024
    s_waitcnt vmcnt(28)
    v_mfma_f32_32x32x16_bf16 v[12:27], v[108:111], v[116:119], v[12:27]
    v_mfma_f32_32x32x16_bf16 v[28:43], v[108:111], v[120:123], v[28:43]
    v_mfma_f32_32x32x16_bf16 v[44:59], v[112:115], v[116:119], v[44:59]
    v_mfma_f32_32x32x16_bf16 v[60:75], v[112:115], v[120:123], v[60:75]
    buffer_load_dwordx4 v[108:111], v4, s[4:7], s22 offen offset:2048
    buffer_load_dwordx4 v[112:115], v4, s[4:7], s23 offen offset:2048
    buffer_load_dwordx4 v[116:119], v4, s[4:7], s20 offen offset:2048
    buffer_load_dwordx4 v[120:123], v4, s[4:7], s21 offen offset:2048
    s_waitcnt vmcnt(28)
    v_mfma_f32_32x32x16_bf16 v[12:27], v[124:127], v[132:135], v[12:27]
    v_mfma_f32_32x32x16_bf16 v[28:43], v[124:127], v[136:139], v[28:43]
    v_mfma_f32_32x32x16_bf16 v[44:59], v[128:131], v[132:135], v[44:59]
    v_mfma_f32_32x32x16_bf16 v[60:75], v[128:131], v[136:139], v[60:75]
    buffer_load_dwordx4 v[124:127], v4, s[4:7], s22 offen offset:3072
    buffer_load_dwordx4 v[128:131], v4, s[4:7], s23 offen offset:3072
    buffer_load_dwordx4 v[132:135], v4, s[4:7], s20 offen offset:3072
    buffer_load_dwordx4 v[136:139], v4, s[4:7], s21 offen offset:3072
    s_waitcnt vmcnt(28)
    v_mfma_f32_32x32x16_bf16 v[12:27], v[140:143], v[148:151], v[12:27]
    v_mfma_f32_32x32x16_bf16 v[28:43], v[140:143], v[152:155], v[28:43]
    v_mfma_f32_32x32x16_bf16 v[44:59], v[144:147], v[148:151], v[44:59]
    v_mfma_f32_32x32x16_bf16 v[60:75], v[144:147], v[152:155], v[60:75]
    s_waitcnt vmcnt(24)
    v_mfma_f32_32x32x16_bf16 v[12:27], v[156:159], v[164:167], v[12:27]
    v_mfma_f32_32x32x16_bf16 v[28:43], v[156:159], v[168:171], v[28:43]
    v_mfma_f32_32x32x16_bf16 v[44:59], v[160:163], v[164:167], v[44:59]
    v_mfma_f32_32x32x16_bf16 v[60:75], v[160:163], v[168:171], v[60:75]
    s_waitcnt vmcnt(20)
    v_mfma_f32_32x32x16_bf16 v[12:27], v[172:175], v[180:183], v[12:27]
    v_mfma_f32_32x32x16_bf16 v[28:43], v[172:175], v[184:187], v[28:43]
    v_mfma_f32_32x32x16_bf16 v[44:59], v[176:179], v[180:183], v[44:59]
    v_mfma_f32_32x32x16_bf16 v[60:75], v[176:179], v[184:187], v[60:75]
    s_waitcnt vmcnt(16)
    v_mfma_f32_32x32x16_bf16 v[12:27], v[188:191], v[196:199], v[12:27]
    v_mfma_f32_32x32x16_bf16 v[28:43], v[188:191], v[200:203], v[28:43]
    v_mfma_f32_32x32x16_bf16 v[44:59], v[192:195], v[196:199], v[44:59]
    v_mfma_f32_32x32x16_bf16 v[60:75], v[192:195], v[200:203], v[60:75]
    s_waitcnt vmcnt(12)
    v_mfma_f32_32x32x16_bf16 v[12:27], v[76:79], v[84:87], v[12:27]
    v_mfma_f32_32x32x16_bf16 v[28:43], v[76:79], v[88:91], v[28:43]
    v_mfma_f32_32x32x16_bf16 v[44:59], v[80:83], v[84:87], v[44:59]
    v_mfma_f32_32x32x16_bf16 v[60:75], v[80:83], v[88:91], v[60:75]
    s_waitcnt vmcnt(8)
    v_mfma_f32_32x32x16_bf16 v[12:27], v[92:95], v[100:103], v[12:27]
    v_mfma_f32_32x32x16_bf16 v[28:43], v[92:95], v[104:107], v[28:43]
    v_mfma_f32_32x32x16_bf16 v[44:59], v[96:99], v[100:103], v[44:59]
    v_mfma_f32_32x32x16_bf16 v[60:75], v[96:99], v[104:107], v[60:75]
    s_waitcnt vmcnt(4)
    v_mfma_f32_32x32x16_bf16 v[12:27], v[108:111], v[116:119], v[12:27]
    v_mfma_f32_32x32x16_bf16 v[28:43], v[108:111], v[120:123], v[28:43]
    v_mfma_f32_32x32x16_bf16 v[44:59], v[112:115], v[116:119], v[44:59]
    v_mfma_f32_32x32x16_bf16 v[60:75], v[112:115], v[120:123], v[60:75]
    s_waitcnt vmcnt(0)
    v_mfma_f32_32x32x16_bf16 v[12:27], v[124:127], v[132:135], v[12:27]
    v_mfma_f32_32x32x16_bf16 v[28:43], v[124:127], v[136:139], v[28:43]
    v_mfma_f32_32x32x16_bf16 v[44:59], v[128:131], v[132:135], v[44:59]
    v_mfma_f32_32x32x16_bf16 v[60:75], v[128:131], v[136:139], v[60:75]
    s_nop 7
    s_nop 7
    v_add_u32 v5, 131072, v4
    s_sub_u32 s11, s8, 4
    s_cmp_lg_u32 s11, 0
    s_cbranch_scc1 L_k2_red1
    ds_write_b128 v5, v[28:31] offset:0
    ds_write_b128 v5, v[32:35] offset:1024
    ds_write_b128 v5, v[36:39] offset:2048
    ds_write_b128 v5, v[40:43] offset:3072
    ds_write_b128 v5, v[60:63] offset:4096
    ds_write_b128 v5, v[64:67] offset:5120
    ds_write_b128 v5, v[68:71] offset:6144
    ds_write_b128 v5, v[72:75] offset:7168
    s_waitcnt lgkmcnt(0)
    s_barrier
    ds_read_b128 v[76:79], v5 offset:8192
    ds_read_b128 v[80:83], v5 offset:9216
    ds_read_b128 v[84:87], v5 offset:10240
    ds_read_b128 v[88:91], v5 offset:11264
    ds_read_b128 v[92:95], v5 offset:12288
    ds_read_b128 v[96:99], v5 offset:13312
    ds_read_b128 v[100:103], v5 offset:14336
    ds_read_b128 v[104:107], v5 offset:15360
    s_waitcnt lgkmcnt(0)
    v_add_f32 v44, v44, v92
    v_add_f32 v45, v45, v93
    v_add_f32 v46, v46, v94
    v_add_f32 v47, v47, v95
    v_add_f32 v48, v48, v96
    v_add_f32 v49, v49, v97
    v_add_f32 v50, v50, v98
    v_add_f32 v51, v51, v99
    v_add_f32 v52, v52, v100
    v_add_f32 v53, v53, v101
    v_add_f32 v54, v54, v102
    v_add_f32 v55, v55, v103
    v_add_f32 v56, v56, v104
    v_add_f32 v57, v57, v105
    v_add_f32 v58, v58, v106
    v_add_f32 v59, v59, v107
    ds_write_b128 v5, v[44:47] offset:8192
    ds_write_b128 v5, v[48:51] offset:9216
    ds_write_b128 v5, v[52:55] offset:10240
    ds_write_b128 v5, v[56:59] offset:11264
    v_add_f32 v12, v12, v76
    v_add_f32 v13, v13, v77
    v_add_f32 v14, v14, v78
    v_add_f32 v15, v15, v79
    v_add_f32 v16, v16, v80
    v_add_f32 v17, v17, v81
    v_add_f32 v18, v18, v82
    v_add_f32 v19, v19, v83
    v_add_f32 v20, v20, v84
    v_add_f32 v21, v21, v85
    v_add_f32 v22, v22, v86
    v_add_f32 v23, v23, v87
    v_add_f32 v24, v24, v88
    v_add_f32 v25, v25, v89
    v_add_f32 v26, v26, v90
    v_add_f32 v27, v27, v91
    s_waitcnt lgkmcnt(0)
    s_barrier
    ds_read_b128 v[76:79], v5 offset:24576
    ds_read_b128 v[80:83], v5 offset:25600
    ds_read_b128 v[84:87], v5 offset:26624
    ds_read_b128 v[88:91], v5 offset:27648
    s_waitcnt lgkmcnt(0)
    v_add_f32 v12, v12, v76
    v_add_f32 v13, v13, v77
    v_add_f32 v14, v14, v78
    v_add_f32 v15, v15, v79
    v_add_f32 v16, v16, v80
    v_add_f32 v17, v17, v81
    v_add_f32 v18, v18, v82
    v_add_f32 v19, v19, v83
    v_add_f32 v20, v20, v84
    v_add_f32 v21, v21, v85
    v_add_f32 v22, v22, v86
    v_add_f32 v23, v23, v87
    v_add_f32 v24, v24, v88
    v_add_f32 v25, v25, v89
    v_add_f32 v26, v26, v90
    v_add_f32 v27, v27, v91
    s_branch L_k2_fend
L_k2_red1:
    s_cmp_lg_u32 s11, 1
    s_cbranch_scc1 L_k2_red2
    ds_write_b128 v5, v[12:15] offset:8192
    ds_write_b128 v5, v[16:19] offset:9216
    ds_write_b128 v5, v[20:23] offset:10240
    ds_write_b128 v5, v[24:27] offset:11264
    ds_write_b128 v5, v[44:47] offset:12288
    ds_write_b128 v5, v[48:51] offset:13312
    ds_write_b128 v5, v[52:55] offset:14336
    ds_write_b128 v5, v[56:59] offset:15360
    s_waitcnt lgkmcnt(0)
    s_barrier
    ds_read_b128 v[76:79], v5 offset:0
    ds_read_b128 v[80:83], v5 offset:1024
    ds_read_b128 v[84:87], v5 offset:2048
    ds_read_b128 v[88:91], v5 offset:3072
    ds_read_b128 v[92:95], v5 offset:4096
    ds_read_b128 v[96:99], v5 offset:5120
    ds_read_b128 v[100:103], v5 offset:6144
    ds_read_b128 v[104:107], v5 offset:7168
    s_waitcnt lgkmcnt(0)
    v_add_f32 v60, v60, v92
    v_add_f32 v61, v61, v93
    v_add_f32 v62, v62, v94
    v_add_f32 v63, v63, v95
    v_add_f32 v64, v64, v96
    v_add_f32 v65, v65, v97
    v_add_f32 v66, v66, v98
    v_add_f32 v67, v67, v99
    v_add_f32 v68, v68, v100
    v_add_f32 v69, v69, v101
    v_add_f32 v70, v70, v102
    v_add_f32 v71, v71, v103
    v_add_f32 v72, v72, v104
    v_add_f32 v73, v73, v105
    v_add_f32 v74, v74, v106
    v_add_f32 v75, v75, v107
    ds_write_b128 v5, v[60:63] offset:0
    ds_write_b128 v5, v[64:67] offset:1024
    ds_write_b128 v5, v[68:71] offset:2048
    ds_write_b128 v5, v[72:75] offset:3072
    v_add_f32 v28, v28, v76
    v_add_f32 v29, v29, v77
    v_add_f32 v30, v30, v78
    v_add_f32 v31, v31, v79
    v_add_f32 v32, v32, v80
    v_add_f32 v33, v33, v81
    v_add_f32 v34, v34, v82
    v_add_f32 v35, v35, v83
    v_add_f32 v36, v36, v84
    v_add_f32 v37, v37, v85
    v_add_f32 v38, v38, v86
    v_add_f32 v39, v39, v87
    v_add_f32 v40, v40, v88
    v_add_f32 v41, v41, v89
    v_add_f32 v42, v42, v90
    v_add_f32 v43, v43, v91
    s_waitcnt lgkmcnt(0)
    s_barrier
    ds_read_b128 v[76:79], v5 offset:16384
    ds_read_b128 v[80:83], v5 offset:17408
    ds_read_b128 v[84:87], v5 offset:18432
    ds_read_b128 v[88:91], v5 offset:19456
    s_waitcnt lgkmcnt(0)
    v_add_f32 v12, v28, v76
    v_add_f32 v13, v29, v77
    v_add_f32 v14, v30, v78
    v_add_f32 v15, v31, v79
    v_add_f32 v16, v32, v80
    v_add_f32 v17, v33, v81
    v_add_f32 v18, v34, v82
    v_add_f32 v19, v35, v83
    v_add_f32 v20, v36, v84
    v_add_f32 v21, v37, v85
    v_add_f32 v22, v38, v86
    v_add_f32 v23, v39, v87
    v_add_f32 v24, v40, v88
    v_add_f32 v25, v41, v89
    v_add_f32 v26, v42, v90
    v_add_f32 v27, v43, v91
    s_branch L_k2_fend
L_k2_red2:
    s_cmp_lg_u32 s11, 2
    s_cbranch_scc1 L_k2_red3
    ds_write_b128 v5, v[28:31] offset:16384
    ds_write_b128 v5, v[32:35] offset:17408
    ds_write_b128 v5, v[36:39] offset:18432
    ds_write_b128 v5, v[40:43] offset:19456
    ds_write_b128 v5, v[60:63] offset:20480
    ds_write_b128 v5, v[64:67] offset:21504
    ds_write_b128 v5, v[68:71] offset:22528
    ds_write_b128 v5, v[72:75] offset:23552
    s_waitcnt lgkmcnt(0)
    s_barrier
    ds_read_b128 v[76:79], v5 offset:24576
    ds_read_b128 v[80:83], v5 offset:25600
    ds_read_b128 v[84:87], v5 offset:26624
    ds_read_b128 v[88:91], v5 offset:27648
    ds_read_b128 v[92:95], v5 offset:28672
    ds_read_b128 v[96:99], v5 offset:29696
    ds_read_b128 v[100:103], v5 offset:30720
    ds_read_b128 v[104:107], v5 offset:31744
    s_waitcnt lgkmcnt(0)
    v_add_f32 v12, v12, v76
    v_add_f32 v13, v13, v77
    v_add_f32 v14, v14, v78
    v_add_f32 v15, v15, v79
    v_add_f32 v16, v16, v80
    v_add_f32 v17, v17, v81
    v_add_f32 v18, v18, v82
    v_add_f32 v19, v19, v83
    v_add_f32 v20, v20, v84
    v_add_f32 v21, v21, v85
    v_add_f32 v22, v22, v86
    v_add_f32 v23, v23, v87
    v_add_f32 v24, v24, v88
    v_add_f32 v25, v25, v89
    v_add_f32 v26, v26, v90
    v_add_f32 v27, v27, v91
    ds_write_b128 v5, v[12:15] offset:24576
    ds_write_b128 v5, v[16:19] offset:25600
    ds_write_b128 v5, v[20:23] offset:26624
    ds_write_b128 v5, v[24:27] offset:27648
    v_add_f32 v44, v44, v92
    v_add_f32 v45, v45, v93
    v_add_f32 v46, v46, v94
    v_add_f32 v47, v47, v95
    v_add_f32 v48, v48, v96
    v_add_f32 v49, v49, v97
    v_add_f32 v50, v50, v98
    v_add_f32 v51, v51, v99
    v_add_f32 v52, v52, v100
    v_add_f32 v53, v53, v101
    v_add_f32 v54, v54, v102
    v_add_f32 v55, v55, v103
    v_add_f32 v56, v56, v104
    v_add_f32 v57, v57, v105
    v_add_f32 v58, v58, v106
    v_add_f32 v59, v59, v107
    s_waitcnt lgkmcnt(0)
    s_barrier
    ds_read_b128 v[76:79], v5 offset:8192
    ds_read_b128 v[80:83], v5 offset:9216
    ds_read_b128 v[84:87], v5 offset:10240
    ds_read_b128 v[88:91], v5 offset:11264
    s_waitcnt lgkmcnt(0)
    v_add_f32 v12, v44, v76
    v_add_f32 v13, v45, v77
    v_add_f32 v14, v46, v78
    v_add_f32 v15, v47, v79
    v_add_f32 v16, v48, v80
    v_add_f32 v17, v49, v81
    v_add_f32 v18, v50, v82
    v_add_f32 v19, v51, v83
    v_add_f32 v20, v52, v84
    v_add_f32 v21, v53, v85
    v_add_f32 v22, v54, v86
    v_add_f32 v23, v55, v87
    v_add_f32 v24, v56, v88
    v_add_f32 v25, v57, v89
    v_add_f32 v26, v58, v90
    v_add_f32 v27, v59, v91
    s_branch L_k2_fend
L_k2_red3:
    ds_write_b128 v5, v[12:15] offset:24576
    ds_write_b128 v5, v[16:19] offset:25600
    ds_write_b128 v5, v[20:23] offset:26624
    ds_write_b128 v5, v[24:27] offset:27648
    ds_write_b128 v5, v[44:47] offset:28672
    ds_write_b128 v5, v[48:51] offset:29696
    ds_write_b128 v5, v[52:55] offset:30720
    ds_write_b128 v5, v[56:59] offset:31744
    s_waitcnt lgkmcnt(0)
    s_barrier
    ds_read_b128 v[76:79], v5 offset:16384
    ds_read_b128 v[80:83], v5 offset:17408
    ds_read_b128 v[84:87], v5 offset:18432
    ds_read_b128 v[88:91], v5 offset:19456
    ds_read_b128 v[92:95], v5 offset:20480
    ds_read_b128 v[96:99], v5 offset:21504
    ds_read_b128 v[100:103], v5 offset:22528
    ds_read_b128 v[104:107], v5 offset:23552
    s_waitcnt lgkmcnt(0)
    v_add_f32 v28, v28, v76
    v_add_f32 v29, v29, v77
    v_add_f32 v30, v30, v78
    v_add_f32 v31, v31, v79
    v_add_f32 v32, v32, v80
    v_add_f32 v33, v33, v81
    v_add_f32 v34, v34, v82
    v_add_f32 v35, v35, v83
    v_add_f32 v36, v36, v84
    v_add_f32 v37, v37, v85
    v_add_f32 v38, v38, v86
    v_add_f32 v39, v39, v87
    v_add_f32 v40, v40, v88
    v_add_f32 v41, v41, v89
    v_add_f32 v42, v42, v90
    v_add_f32 v43, v43, v91
    ds_write_b128 v5, v[28:31] offset:16384
    ds_write_b128 v5, v[32:35] offset:17408
    ds_write_b128 v5, v[36:39] offset:18432
    ds_write_b128 v5, v[40:43] offset:19456
    v_add_f32 v60, v60, v92
    v_add_f32 v61, v61, v93
    v_add_f32 v62, v62, v94
    v_add_f32 v63, v63, v95
    v_add_f32 v64, v64, v96
    v_add_f32 v65, v65, v97
    v_add_f32 v66, v66, v98
    v_add_f32 v67, v67, v99
    v_add_f32 v68, v68, v100
    v_add_f32 v69, v69, v101
    v_add_f32 v70, v70, v102
    v_add_f32 v71, v71, v103
    v_add_f32 v72, v72, v104
    v_add_f32 v73, v73, v105
    v_add_f32 v74, v74, v106
    v_add_f32 v75, v75, v107
    s_waitcnt lgkmcnt(0)
    s_barrier
    ds_read_b128 v[76:79], v5 offset:0
    ds_read_b128 v[80:83], v5 offset:1024
    ds_read_b128 v[84:87], v5 offset:2048
    ds_read_b128 v[88:91], v5 offset:3072
    s_waitcnt lgkmcnt(0)
    v_add_f32 v12, v60, v76
    v_add_f32 v13, v61, v77
    v_add_f32 v14, v62, v78
    v_add_f32 v15, v63, v79
    v_add_f32 v16, v64, v80
    v_add_f32 v17, v65, v81
    v_add_f32 v18, v66, v82
    v_add_f32 v19, v67, v83
    v_add_f32 v20, v68, v84
    v_add_f32 v21, v69, v85
    v_add_f32 v22, v70, v86
    v_add_f32 v23, v71, v87
    v_add_f32 v24, v72, v88
    v_add_f32 v25, v73, v89
    v_add_f32 v26, v74, v90
    v_add_f32 v27, v75, v91
L_k2_fend:
    s_mov_b32 s28, s26
    s_mov_b32 s29, s27
    s_mov_b32 s30, 0x200000
    s_mov_b32 s31, 0x00020000
    s_sub_u32 s16, s8, 4
    s_lshr_b32 s17, s16, 1
    s_and_b32 s20, s16, 1
    s_lshl_b32 s11, s17, 14
    s_lshl_b32 s23, s10, 16
    s_add_u32 s23, s23, s11
    s_add_u32 s23, s23, 15466496
    s_lshl_b32 s22, s17, 15
    s_xor_b32 s24, s22, 32768
    s_add_u32 s24, s24, s23
    s_add_u32 s23, s23, s22
    s_lshl_b32 s21, s9, 16
    s_add_u32 s21, s21, s11
    s_lshl_b32 s11, s20, 15
    s_add_u32 s21, s21, s11
    s_add_u32 s21, s21, 2097152
    s_add_u32 s11, s10, 1
    s_and_b32 s11, s11, 3
    s_lshl_b32 s11, s11, 12
    s_add_u32 s32, s21, s11
    s_add_u32 s36, s23, s11
    s_add_u32 s37, s24, s11
    buffer_load_dwordx4 v[28:31], v4, s[4:7], s36 offen offset:0
    buffer_load_dwordx4 v[32:35], v4, s[4:7], s37 offen offset:0
    buffer_load_dwordx4 v[36:39], v4, s[4:7], s36 offen offset:1024
    buffer_load_dwordx4 v[40:43], v4, s[4:7], s37 offen offset:1024
    buffer_load_dwordx4 v[44:47], v4, s[4:7], s36 offen offset:2048
    buffer_load_dwordx4 v[48:51], v4, s[4:7], s37 offen offset:2048
    buffer_load_dwordx4 v[52:55], v4, s[4:7], s36 offen offset:3072
    buffer_load_dwordx4 v[56:59], v4, s[4:7], s37 offen offset:3072
    s_add_u32 s11, s10, 2
    s_and_b32 s11, s11, 3
    s_lshl_b32 s11, s11, 12
    s_add_u32 s33, s21, s11
    s_add_u32 s36, s23, s11
    s_add_u32 s37, s24, s11
    buffer_load_dwordx4 v[60:63], v4, s[4:7], s36 offen offset:0
    buffer_load_dwordx4 v[64:67], v4, s[4:7], s37 offen offset:0
    buffer_load_dwordx4 v[68:71], v4, s[4:7], s36 offen offset:1024
    buffer_load_dwordx4 v[72:75], v4, s[4:7], s37 offen offset:1024
    buffer_load_dwordx4 v[76:79], v4, s[4:7], s36 offen offset:2048
    buffer_load_dwordx4 v[80:83], v4, s[4:7], s37 offen offset:2048
    buffer_load_dwordx4 v[84:87], v4, s[4:7], s36 offen offset:3072
    buffer_load_dwordx4 v[88:91], v4, s[4:7], s37 offen offset:3072
    s_add_u32 s11, s10, 3
    s_and_b32 s11, s11, 3
    s_lshl_b32 s11, s11, 12
    s_add_u32 s34, s21, s11
    s_add_u32 s36, s23, s11
    s_add_u32 s37, s24, s11
    buffer_load_dwordx4 v[92:95], v4, s[4:7], s36 offen offset:0
    buffer_load_dwordx4 v[96:99], v4, s[4:7], s37 offen offset:0
    buffer_load_dwordx4 v[100:103], v4, s[4:7], s36 offen offset:1024
    buffer_load_dwordx4 v[104:107], v4, s[4:7], s37 offen offset:1024
    buffer_load_dwordx4 v[108:111], v4, s[4:7], s36 offen offset:2048
    buffer_load_dwordx4 v[112:115], v4, s[4:7], s37 offen offset:2048
    buffer_load_dwordx4 v[116:119], v4, s[4:7], s36 offen offset:3072
    buffer_load_dwordx4 v[120:123], v4, s[4:7], s37 offen offset:3072
    s_add_u32 s11, s10, 4
    s_and_b32 s11, s11, 3
    s_lshl_b32 s11, s11, 12
    s_add_u32 s35, s21, s11
    s_add_u32 s36, s23, s11
    s_add_u32 s37, s24, s11
    buffer_load_dwordx4 v[124:127], v4, s[4:7], s36 offen offset:0
    buffer_load_dwordx4 v[128:131], v4, s[4:7], s37 offen offset:0
    buffer_load_dwordx4 v[132:135], v4, s[4:7], s36 offen offset:1024
    buffer_load_dwordx4 v[136:139], v4, s[4:7], s37 offen offset:1024
    buffer_load_dwordx4 v[140:143], v4, s[4:7], s36 offen offset:2048
    buffer_load_dwordx4 v[144:147], v4, s[4:7], s37 offen offset:2048
    buffer_load_dwordx4 v[148:151], v4, s[4:7], s36 offen offset:3072
    buffer_load_dwordx4 v[152:155], v4, s[4:7], s37 offen offset:3072
    s_lshl_b32 s21, s9, 1
    s_add_u32 s21, s21, s20
    s_lshl_b32 s22, s10, 1
    s_add_u32 s22, s22, s17
    v_and_b32 v6, 31, v1
    v_lshlrev_b32 v9, 2, v6
    s_lshl_b32 s11, s21, 7
    s_add_u32 s11, s11, 16121856
    buffer_load_dword v5, v9, s[4:7], s11 offen
    v_lshlrev_b32 v6, 10, v6
    v_lshrrev_b32 v8, 5, v1
    v_lshl_add_u32 v6, v8, 5, v6
    s_lshl_b32 s25, s21, 15
    s_lshl_b32 s11, s22, 6
    s_add_u32 s25, s25, s11
    s_xor_b32 s11, s16, 2
    s_lshl_b32 s11, s11, 12
    v_add_u32 v7, s11, v4
    s_lshl_b32 s11, s16, 12
    v_add_u32 v8, s11, v4
    s_mov_b32 s14, 0
    s_waitcnt vmcnt(0)
    v_sub_f32 v9, 1.0, v5
    v_mul_f32 v12, v9, v12
    v_mul_f32 v13, v9, v13
    v_mul_f32 v14, v9, v14
    v_mul_f32 v15, v9, v15
    v_mul_f32 v16, v9, v16
    v_mul_f32 v17, v9, v17
    v_mul_f32 v18, v9, v18
    v_mul_f32 v19, v9, v19
    v_mul_f32 v20, v9, v20
    v_mul_f32 v21, v9, v21
    v_mul_f32 v22, v9, v22
    v_mul_f32 v23, v9, v23
    v_mul_f32 v24, v9, v24
    v_mul_f32 v25, v9, v25
    v_mul_f32 v26, v9, v26
    v_mul_f32 v27, v9, v27
    s_barrier
    buffer_load_dwordx4 v[156:159], v4, s[4:7], s32 offen offset:0 sc1
    buffer_load_dwordx4 v[160:163], v4, s[4:7], s32 offen offset:1024 sc1
    buffer_load_dwordx4 v[164:167], v4, s[4:7], s32 offen offset:2048 sc1
    buffer_load_dwordx4 v[168:171], v4, s[4:7], s32 offen offset:3072 sc1
    buffer_load_dwordx4 v[172:175], v4, s[4:7], s33 offen offset:0 sc1
    buffer_load_dwordx4 v[176:179], v4, s[4:7], s33 offen offset:1024 sc1
    buffer_load_dwordx4 v[180:183], v4, s[4:7], s33 offen offset:2048 sc1
    buffer_load_dwordx4 v[184:187], v4, s[4:7], s33 offen offset:3072 sc1
    buffer_load_dwordx4 v[188:191], v4, s[4:7], s34 offen offset:0 sc1
    buffer_load_dwordx4 v[192:195], v4, s[4:7], s34 offen offset:1024 sc1
    buffer_load_dwordx4 v[196:199], v4, s[4:7], s34 offen offset:2048 sc1
    buffer_load_dwordx4 v[200:203], v4, s[4:7], s34 offen offset:3072 sc1
    buffer_load_dwordx4 v[204:207], v4, s[4:7], s35 offen offset:0 sc1
    buffer_load_dwordx4 v[208:211], v4, s[4:7], s35 offen offset:1024 sc1
    buffer_load_dwordx4 v[212:215], v4, s[4:7], s35 offen offset:2048 sc1
    buffer_load_dwordx4 v[216:219], v4, s[4:7], s35 offen offset:3072 sc1
    s_waitcnt vmcnt(12)
L_k2_chk0:
    v_max3_u32 v9, v156, v157, v158
    v_max3_u32 v10, v159, v160, v161
    v_max3_u32 v9, v162, v163, v9
    v_max3_u32 v10, v164, v165, v10
    v_max3_u32 v9, v166, v167, v9
    v_max3_u32 v10, v168, v169, v10
    v_max3_u32 v9, v170, v171, v9
    v_max_u32 v9, v9, v10
    v_cmp_eq_u32 vcc, -1, v9
    s_nop 1
    s_cbranch_vccnz L_k2_slow0
L_k2_go0:
    v_mfma_f32_32x32x16_bf16 v[220:235], v[28:31], v[156:159], 0
    v_mfma_f32_32x32x16_bf16 v[236:251], v[32:35], v[156:159], 0
    v_mfma_f32_32x32x16_bf16 v[220:235], v[36:39], v[160:163], v[220:235]
    v_mfma_f32_32x32x16_bf16 v[236:251], v[40:43], v[160:163], v[236:251]
    v_mfma_f32_32x32x16_bf16 v[220:235], v[44:47], v[164:167], v[220:235]
    v_mfma_f32_32x32x16_bf16 v[236:251], v[48:51], v[164:167], v[236:251]
    v_mfma_f32_32x32x16_bf16 v[220:235], v[52:55], v[168:171], v[220:235]
    v_mfma_f32_32x32x16_bf16 v[236:251], v[56:59], v[168:171], v[236:251]
    s_waitcnt vmcnt(8)
L_k2_chk1:
    v_max3_u32 v9, v172, v173, v174
    v_max3_u32 v10, v175, v176, v177
    v_max3_u32 v9, v178, v179, v9
    v_max3_u32 v10, v180, v181, v10
    v_max3_u32 v9, v182, v183, v9
    v_max3_u32 v10, v184, v185, v10
    v_max3_u32 v9, v186, v187, v9
    v_max_u32 v9, v9, v10
    v_cmp_eq_u32 vcc, -1, v9
    s_nop 1
    s_cbranch_vccnz L_k2_slow1
L_k2_go1:
    v_mfma_f32_32x32x16_bf16 v[220:235], v[60:63], v[172:175], v[220:235]
    v_mfma_f32_32x32x16_bf16 v[236:251], v[64:67], v[172:175], v[236:251]
    v_mfma_f32_32x32x16_bf16 v[220:235], v[68:71], v[176:179], v[220:235]
    v_mfma_f32_32x32x16_bf16 v[236:251], v[72:75], v[176:179], v[236:251]
    v_mfma_f32_32x32x16_bf16 v[220:235], v[76:79], v[180:183], v[220:235]
    v_mfma_f32_32x32x16_bf16 v[236:251], v[80:83], v[180:183], v[236:251]
    v_mfma_f32_32x32x16_bf16 v[220:235], v[84:87], v[184:187], v[220:235]
    v_mfma_f32_32x32x16_bf16 v[236:251], v[88:91], v[184:187], v[236:251]
    s_waitcnt vmcnt(4)
L_k2_chk2:
    v_max3_u32 v9, v188, v189, v190
    v_max3_u32 v10, v191, v192, v193
    v_max3_u32 v9, v194, v195, v9
    v_max3_u32 v10, v196, v197, v10
    v_max3_u32 v9, v198, v199, v9
    v_max3_u32 v10, v200, v201, v10
    v_max3_u32 v9, v202, v203, v9
    v_max_u32 v9, v9, v10
    v_cmp_eq_u32 vcc, -1, v9
    s_nop 1
    s_cbranch_vccnz L_k2_slow2
L_k2_go2:
    v_mfma_f32_32x32x16_bf16 v[220:235], v[92:95], v[188:191], v[220:235]
    v_mfma_f32_32x32x16_bf16 v[236:251], v[96:99], v[188:191], v[236:251]
    v_mfma_f32_32x32x16_bf16 v[220:235], v[100:103], v[192:195], v[220:235]
    v_mfma_f32_32x32x16_bf16 v[236:251], v[104:107], v[192:195], v[236:251]
    v_mfma_f32_32x32x16_bf16 v[220:235], v[108:111], v[196:199], v[220:235]
    v_mfma_f32_32x32x16_bf16 v[236:251], v[112:115], v[196:199], v[236:251]
    v_mfma_f32_32x32x16_bf16 v[220:235], v[116:119], v[200:203], v[220:235]
    v_mfma_f32_32x32x16_bf16 v[236:251], v[120:123], v[200:203], v[236:251]
    s_waitcnt vmcnt(0)
L_k2_chk3:
    v_max3_u32 v9, v204, v205, v206
    v_max3_u32 v10, v207, v208, v209
    v_max3_u32 v9, v210, v211, v9
    v_max3_u32 v10, v212, v213, v10
    v_max3_u32 v9, v214, v215, v9
    v_max3_u32 v10, v216, v217, v10
    v_max3_u32 v9, v218, v219, v9
    v_max_u32 v9, v9, v10
    v_cmp_eq_u32 vcc, -1, v9
    s_nop 1
    s_cbranch_vccnz L_k2_slow3
L_k2_go3:
    v_mfma_f32_32x32x16_bf16 v[220:235], v[124:127], v[204:207], v[220:235]
    v_mfma_f32_32x32x16_bf16 v[236:251], v[128:131], v[204:207], v[236:251]
    v_mfma_f32_32x32x16_bf16 v[220:235], v[132:135], v[208:211], v[220:235]
    v_mfma_f32_32x32x16_bf16 v[236:251], v[136:139], v[208:211], v[236:251]
    v_mfma_f32_32x32x16_bf16 v[220:235], v[140:143], v[212:215], v[220:235]
    v_mfma_f32_32x32x16_bf16 v[236:251], v[144:147], v[212:215], v[236:251]
    v_mfma_f32_32x32x16_bf16 v[220:235], v[148:151], v[216:219], v[220:235]
    v_mfma_f32_32x32x16_bf16 v[236:251], v[152:155], v[216:219], v[236:251]
    s_nop 7
    s_nop 7
    ds_write_b128 v7, v[236:239] offset:0
    ds_write_b128 v7, v[240:243] offset:1024
    ds_write_b128 v7, v[244:247] offset:2048
    ds_write_b128 v7, v[248:251] offset:3072
    v_fma_f32 v12, v5, v220, v12
    v_fma_f32 v13, v5, v221, v13
    v_fma_f32 v14, v5, v222, v14
    v_fma_f32 v15, v5, v223, v15
    v_fma_f32 v16, v5, v224, v16
    v_fma_f32 v17, v5, v225, v17
    v_fma_f32 v18, v5, v226, v18
    v_fma_f32 v19, v5, v227, v19
    v_fma_f32 v20, v5, v228, v20
    v_fma_f32 v21, v5, v229, v21
    v_fma_f32 v22, v5, v230, v22
    v_fma_f32 v23, v5, v231, v23
    v_fma_f32 v24, v5, v232, v24
    v_fma_f32 v25, v5, v233, v25
    v_fma_f32 v26, v5, v234, v26
    v_fma_f32 v27, v5, v235, v27
    s_waitcnt lgkmcnt(0)
    s_barrier
    ds_read_b128 v[28:31], v8 offset:0
    ds_read_b128 v[32:35], v8 offset:1024
    ds_read_b128 v[36:39], v8 offset:2048
    ds_read_b128 v[40:43], v8 offset:3072
    s_waitcnt lgkmcnt(3)
    v_fma_f32 v12, v5, v28, v12
    v_fma_f32 v13, v5, v29, v13
    v_fma_f32 v14, v5, v30, v14
    v_fma_f32 v15, v5, v31, v15
    v_cvt_pk_bf16_f32 v220, v12, v13
    v_cvt_pk_bf16_f32 v221, v14, v15
    s_waitcnt lgkmcnt(2)
    v_fma_f32 v16, v5, v32, v16
    v_fma_f32 v17, v5, v33, v17
    v_fma_f32 v18, v5, v34, v18
    v_fma_f32 v19, v5, v35, v19
    v_cvt_pk_bf16_f32 v222, v16, v17
    v_cvt_pk_bf16_f32 v223, v18, v19
    s_waitcnt lgkmcnt(1)
    v_fma_f32 v20, v5, v36, v20
    v_fma_f32 v21, v5, v37, v21
    v_fma_f32 v22, v5, v38, v22
    v_fma_f32 v23, v5, v39, v23
    v_cvt_pk_bf16_f32 v224, v20, v21
    v_cvt_pk_bf16_f32 v225, v22, v23
    s_waitcnt lgkmcnt(0)
    v_fma_f32 v24, v5, v40, v24
    v_fma_f32 v25, v5, v41, v25
    v_fma_f32 v26, v5, v42, v26
    v_fma_f32 v27, v5, v43, v27
    v_cvt_pk_bf16_f32 v226, v24, v25
    v_cvt_pk_bf16_f32 v227, v26, v27
    buffer_store_dwordx4 v[220:223], v6, s[28:31], s25 offen
    buffer_store_dwordx4 v[224:227], v6, s[28:31], s25 offen offset:16
    s_endpgm
L_k2_slow0:
    s_add_u32 s14, s14, 1
    s_cmp_lt_u32 s14, 20000
    s_cbranch_scc0 L_k2_go0
    buffer_load_dwordx4 v[156:159], v4, s[4:7], s32 offen offset:0 sc1
    buffer_load_dwordx4 v[160:163], v4, s[4:7], s32 offen offset:1024 sc1
    buffer_load_dwordx4 v[164:167], v4, s[4:7], s32 offen offset:2048 sc1
    buffer_load_dwordx4 v[168:171], v4, s[4:7], s32 offen offset:3072 sc1
    s_waitcnt vmcnt(0)
    s_branch L_k2_chk0
L_k2_slow1:
    s_add_u32 s14, s14, 1
    s_cmp_lt_u32 s14, 20000
    s_cbranch_scc0 L_k2_go1
    buffer_load_dwordx4 v[172:175], v4, s[4:7], s33 offen offset:0 sc1
    buffer_load_dwordx4 v[176:179], v4, s[4:7], s33 offen offset:1024 sc1
    buffer_load_dwordx4 v[180:183], v4, s[4:7], s33 offen offset:2048 sc1
    buffer_load_dwordx4 v[184:187], v4, s[4:7], s33 offen offset:3072 sc1
    s_waitcnt vmcnt(0)
    s_branch L_k2_chk1
L_k2_slow2:
    s_add_u32 s14, s14, 1
    s_cmp_lt_u32 s14, 20000
    s_cbranch_scc0 L_k2_go2
    buffer_load_dwordx4 v[188:191], v4, s[4:7], s34 offen offset:0 sc1
    buffer_load_dwordx4 v[192:195], v4, s[4:7], s34 offen offset:1024 sc1
    buffer_load_dwordx4 v[196:199], v4, s[4:7], s34 offen offset:2048 sc1
    buffer_load_dwordx4 v[200:203], v4, s[4:7], s34 offen offset:3072 sc1
    s_waitcnt vmcnt(0)
    s_branch L_k2_chk2
L_k2_slow3:
    s_add_u32 s14, s14, 1
    s_cmp_lt_u32 s14, 20000
    s_cbranch_scc0 L_k2_go3
    buffer_load_dwordx4 v[204:207], v4, s[4:7], s35 offen offset:0 sc1
    buffer_load_dwordx4 v[208:211], v4, s[4:7], s35 offen offset:1024 sc1
    buffer_load_dwordx4 v[212:215], v4, s[4:7], s35 offen offset:2048 sc1
    buffer_load_dwordx4 v[216:219], v4, s[4:7], s35 offen offset:3072 sc1
    s_waitcnt vmcnt(0)
    s_branch L_k2_chk3
L_k2_end:
    s_endpgm
.section .rodata,"a"
.p2align 6
.amdhsa_kernel gm_k1_kernel
  .amdhsa_next_free_vgpr 200
  .amdhsa_next_free_sgpr 96
  .amdhsa_accum_offset 200
  .amdhsa_group_segment_fixed_size 0
  .amdhsa_kernarg_size 104
  .amdhsa_user_sgpr_count 2
  .amdhsa_user_sgpr_kernarg_segment_ptr 1
  .amdhsa_system_sgpr_workgroup_id_x 1
.end_amdhsa_kernel
.p2align 6
.amdhsa_kernel gm_k2_kernel
  .amdhsa_next_free_vgpr 252
  .amdhsa_next_free_sgpr 96
  .amdhsa_accum_offset 252
  .amdhsa_group_segment_fixed_size 0
  .amdhsa_kernarg_size 104
  .amdhsa_user_sgpr_count 2
  .amdhsa_user_sgpr_kernarg_segment_ptr 1
  .amdhsa_system_sgpr_workgroup_id_x 1
.end_amdhsa_kernel
```
